```python
import torch

def _softmax(x, axis=-1):
    return torch.softmax(x, dim=axis)
def _gelu(x):
    return torch.nn.functional.gelu(x, approximate="tanh")
def _silu(x):
    return torch.nn.functional.silu(x)
def _sigmoid(x):
    return torch.sigmoid(x)
def _layernorm(x, axis=-1, eps=1e-5):
    m = x.mean(dim=axis, keepdim=True)
    v = x.var(dim=axis, keepdim=True, unbiased=False)
    return (x - m) / torch.sqrt(v + eps)
def _scatter_add(tgt, idx, src, axis=0):
    return tgt.clone().index_add_(axis, idx, src)
def _segment_sum(src, seg, n):
    out = torch.zeros((n,) + src.shape[1:], dtype=src.dtype)
    return out.index_add_(0, seg, src)
def _pad(x, pw):
    flat = tuple(v for pair in reversed(pw) for v in pair)
    return torch.nn.functional.pad(x, flat)

kernel_name = 'gated_mix__linear_attn_block__linear_attn_block__prompt'

def setup_inputs():

    _w = (lambda a: (lambda t: t.to(torch.bfloat16) if t.is_floating_point() else t)(torch.as_tensor(a)))
    def _A_setup():
        B, S, D = 1, 2048, 512
        return {
            "x": _w((lambda *s: torch.randn(*s, dtype=torch.bfloat16) * 0.05)(B, S, D)),
            "wqkv": _w((lambda *s: torch.randn(*s, dtype=torch.bfloat16) * 0.8)(D, 3 * D)),
            "wo": _w((lambda *s: torch.randn(*s, dtype=torch.bfloat16) * 0.05)(D, D)),
        }
    _A_in = _A_setup()

    def _B_setup():
        B, S, D = 1, 2048, 512
        return {
            "x": _w((lambda *s: torch.randn(*s, dtype=torch.bfloat16) * 0.05)(B, S, D)),
            "wqkv": _w((lambda *s: torch.randn(*s, dtype=torch.bfloat16) * 0.8)(D, 3 * D)),
            "wo": _w((lambda *s: torch.randn(*s, dtype=torch.bfloat16) * 0.05)(D, D)),
        }
    _B_in = _B_setup()

    return {
        "A_x": _A_in["x"],
        "A_wqkv": _A_in["wqkv"],
        "A_wo": _A_in["wo"],
        "B_x": _B_in["x"],
        "B_wqkv": _B_in["wqkv"],
        "B_wo": _B_in["wo"],
        "gate_w": _w((lambda *s: torch.randn(*s, dtype=torch.bfloat16) * 0.05)(512) * 16.0),
    }

def reference(A_x, A_wqkv, A_wo, B_x, B_wqkv, B_wo, gate_w):
    def _A_ref(x, wqkv, wo):
        B, S, D = x.shape
        H = 32; Dh = D // H
        qkv = (lambda x, *d: x.permute(*d))((x @ wqkv).reshape(B, S, 3, H, Dh), 2, 0, 3, 1, 4)
        q, k, v = qkv[0], qkv[1], qkv[2]
        phi = lambda t: torch.where(t > 0, t + 1, torch.exp(t)) + 1e-6
        pq, pk = phi(q), phi(k)
        kv = torch.einsum("bhsd,bhse->bhde", pk, v)
        z = torch.einsum("bhsd->bhd", pk)
        num = torch.einsum("bhqd,bhde->bhqe", pq, kv)
        den = torch.einsum("bhqd,bhd->bhq", pq, z)[..., None] + 1e-6
        o = num / den
        return (lambda x, *d: x.permute(*d))(o, 0, 2, 1, 3).reshape(B, S, D) @ wo

    def _B_ref(x, wqkv, wo):
        B, S, D = x.shape
        H = 32; Dh = D // H
        qkv = (lambda x, *d: x.permute(*d))((x @ wqkv).reshape(B, S, 3, H, Dh), 2, 0, 3, 1, 4)
        q, k, v = qkv[0], qkv[1], qkv[2]
        phi = lambda t: torch.where(t > 0, t + 1, torch.exp(t)) + 1e-6
        pq, pk = phi(q), phi(k)
        kv = torch.einsum("bhsd,bhse->bhde", pk, v)
        z = torch.einsum("bhsd->bhd", pk)
        num = torch.einsum("bhqd,bhde->bhqe", pq, kv)
        den = torch.einsum("bhqd,bhd->bhq", pq, z)[..., None] + 1e-6
        o = num / den
        return (lambda x, *d: x.permute(*d))(o, 0, 2, 1, 3).reshape(B, S, D) @ wo

    x = A_x
    g = _sigmoid((x * gate_w).sum(-1, keepdims=True))
    a = _A_ref(x, A_wqkv, A_wo)
    b = _B_ref(x, B_wqkv, B_wo)
    return g * a + (1 - g) * b
```

```asm
; @launch grid=(256,1,1) block=(512,1,1) lds=163840
.amdgcn_target "amdgcn-amd-amdhsa--gfx950"
.text
.globl gated_mix__linear_attn_block__linear_attn_block__prompt_kernel
.p2align 8
.type gated_mix__linear_attn_block__linear_attn_block__prompt_kernel,@function
gated_mix__linear_attn_block__linear_attn_block__prompt_kernel:

    s_load_dwordx2 s[24:25], s[0:1], 0
    s_and_b32 s59, s2, 4
    s_mul_i32 s59, s59, 6
    s_load_dwordx2 s[28:29], s[0:1], s59 offset:8
    v_readfirstlane_b32 s54, v0
    s_cmpk_ge_u32 s2, 256
    s_cbranch_scc1 Lend
    v_and_b32 v1, 63, v0
    s_lshr_b32 s60, s2, 3
    s_and_b32 s49, s60, 7
    s_lshr_b32 s3, s60, 3
    s_and_b32 s52, s2, 1
    s_lshl3_add_u32 s52, s52, s49
    s_lshr_b32 s58, s54, 6
    s_and_b32 s58, s58, 3
    s_cmpk_lt_u32 s54, 256
    s_cbranch_scc1 Lx

    v_lshrrev_b32 v20, 3, v1
    v_and_b32 v21, 7, v1
    v_lshrrev_b32 v22, 4, v1
    v_xor_b32 v23, v21, v22
    v_lshlrev_b32 v2, 10, v20
    v_lshl_add_u32 v2, v23, 4, v2
    s_add_u32 s55, s49, s3
    s_lshl_b32 s55, s55, 2
    s_and_b32 s59, s55, 7
    s_lshl2_add_u32 s56, s52, s58
    s_lshl_b32 s56, s56, 15
    s_lshl_b32 s60, s59, 7
    s_add_u32 s60, s60, s56
    s_lshl_b32 s67, s58, 12
    s_mov_b32 m0, s67
    s_mov_b32 s26, 2097152
    s_mov_b32 s27, 0x20000
    v_xor_b32 v3, 64, v2
    v_add_u32 v3, 7168, v3
    s_waitcnt lgkmcnt(0)
    buffer_load_dwordx4 v2, s[24:27], s60 offen lds
    v_add_u32 v4, 14336, v2
    v_add_u32 v5, 14336, v3
    buffer_load_dwordx4 v3, s[24:27], s60 offen offset:1024 lds
    v_and_b32 v23, 1, v22
    v_lshlrev_b32 v24, 1, v23
    v_xor_b32 v24, v21, v24
    v_mul_u32_u24 v25, 3072, v20
    buffer_load_dwordx4 v4, s[24:27], s60 offen offset:2048 lds
    v_lshl_add_u32 v6, v24, 4, v25
    s_and_b32 s57, s2, 2
    s_lshl1_add_u32 s57, s57, s3
    s_lshl_b32 s57, s57, 7
    s_mul_i32 s66, s58, 49152
    buffer_load_dwordx4 v5, s[24:27], s60 offen offset:3072 lds
    s_add_u32 s66, s66, s57
    s_mul_i32 s61, s59, 196608
    s_add_u32 s61, s61, s66
    s_mov_b32 s30, 1572864
    s_mov_b32 s31, s27
    s_add_u32 m0, s67, 16384
    v_xor_b32 v7, 64, v6
    buffer_load_dwordx4 v6, s[28:31], s61 offen offset:2048 lds
    v_add_u32 v7, 23552, v7
    v_add_u32 v10, 1024, v6
    buffer_load_dwordx4 v7, s[28:31], s61 offen offset:3072 lds
    v_add_u32 v11, 1024, v7
    buffer_load_dwordx4 v10, s[28:31], s61 offen lds
    buffer_load_dwordx4 v11, s[28:31], s61 offen offset:1024 lds

    s_load_dwordx16 s[4:19], s[0:1], 0
    s_load_dwordx4 s[20:23], s[0:1], 64
    s_and_b32 s62, s2, 7
    s_lshl2_add_u32 s48, s62, s3
    s_lshr_b32 s53, s62, 1
    s_lshl2_add_u32 s53, s53, s3
    s_and_b32 s50, s58, 1
    s_lshl1_add_u32 s50, s3, s50
    s_mov_b32 s51, 1

    v_lshlrev_b32 v24, 2, v23
    v_xor_b32 v24, v21, v24
    v_lshl_add_u32 v26, v24, 4, v25
    v_add_u32 v27, 23552, v26
    v_lshlrev_b32 v56, 10, v20
    v_lshl_add_u32 v56, v24, 4, v56
    v_add_u32 v57, 7168, v56
    v_add_u32 v58, 14336, v56
    v_add_u32 v59, 21504, v56
    s_lshr_b32 s68, s49, 1
    s_lshl_b32 s69, s58, 11
    v_lshrrev_b32 v8, 5, v1
    v_and_b32 v24, 3, v1
    v_bfe_u32 v25, v1, 2, 2
    v_lshl_add_u32 v60, v8, 2, v25
    v_lshlrev_b32 v60, 7, v60
    v_lshl_add_u32 v60, v23, 5, v60
    v_lshl_add_u32 v60, v24, 3, v60
    v_bfe_u32 v25, v1, 3, 1
    s_and_b32 s59, s58, 1
    v_xor_b32 v25, s59, v25
    v_lshl_add_u32 v60, v25, 6, v60
    v_lshlrev_b32 v19, 4, v1
    v_mov_b32 v30, 131072
    v_mov_b32 v31, 1
    v_lshlrev_b32 v9, 8, v22
    v_lshl_add_u32 v9, v24, 2, v9
    v_bfe_u32 v25, v1, 2, 1
    v_lshl_add_u32 v9, v25, 5, v9
    v_bfe_u32 v25, v1, 3, 1
    v_lshl_add_u32 v9, v25, 4, v9

    s_cmp_ge_u32 s58, 2
    s_waitcnt lgkmcnt(0)
    s_cselect_b32 s32, s14, s8
    s_cselect_b32 s33, s15, s9
    s_mov_b32 s34, 524288
    s_mov_b32 s35, 0x20000
    s_lshl_b32 s14, s49, 7
    s_lshl_b32 s15, s58, 14
    s_add_u32 s15, s15, 65536
    s_lshl_b32 s63, s58, 13
    v_add_u32 v46, s63, v60
    v_xor_b32 v47, 0x2000, v46
    v_add_u32 v60, s15, v60
    v_xor_b32 v61, 0x4000, v60
    s_lshr_b32 s60, s58, 1
    s_lshl_b32 s60, s60, 2
    s_add_u32 s60, s60, 131088
    v_mov_b32 v62, s60
    s_lshl_b32 s59, s53, 2
    s_add_u32 s59, s59, s58
    s_mul_i32 s12, s59, 1152
    s_add_u32 s12, s12, 5242880
    s_and_b32 s3, s52, 0
    s_mul_i32 s3, s3, 81920
    s_add_u32 s3, s3, s12
    s_lshl_b32 s13, s59, 10
    s_add_u32 s13, s13, 131072
    s_and_b32 s60, s52, 3
    s_mul_i32 s60, s60, 256
    s_add_u32 s13, s13, s60
    s_lshl_b32 s6, s53, 11
    s_add_u32 s6, s6, s56
    s_lshr_b32 s7, s6, 8
    s_add_u32 s7, s7, 262144

    v_mov_b32 v44, 0
    v_mov_b32 v45, 0

    s_mov_b32 s40, s22
    s_mov_b32 s41, s23
    s_mov_b32 s42, 6291456
    s_mov_b32 s43, 0x20000
    s_mov_b32 s44, s18
    s_mov_b32 s45, s19
    s_mov_b32 s46, 2097152
    s_mov_b32 s47, 0x20000
    s_add_u32 s59, s55, 1
    s_and_b32 s59, s59, 7
    s_lshl_b32 s60, s59, 7
    s_add_u32 m0, s67, 32768
    s_add_u32 s60, s60, s56
    buffer_load_dwordx4 v2, s[24:27], s60 offen lds
    s_mul_i32 s61, s59, 196608
    buffer_load_dwordx4 v3, s[24:27], s60 offen offset:1024 lds
    s_add_u32 s61, s61, s66
    buffer_load_dwordx4 v4, s[24:27], s60 offen offset:2048 lds
    buffer_load_dwordx4 v5, s[24:27], s60 offen offset:3072 lds
    s_add_u32 m0, s67, 49152
    s_nop 0
    buffer_load_dwordx4 v10, s[28:31], s61 offen lds
    buffer_load_dwordx4 v11, s[28:31], s61 offen offset:1024 lds
    buffer_load_dwordx4 v6, s[28:31], s61 offen offset:2048 lds
    buffer_load_dwordx4 v7, s[28:31], s61 offen offset:3072 lds
    global_load_dwordx4 v[40:43], v19, s[16:17]
    s_waitcnt vmcnt(9)
    s_barrier
    s_add_u32 s59, s55, 2
    s_and_b32 s59, s59, 7
    s_lshl_b32 s60, s59, 7
    s_add_u32 m0, s67, 65536
    s_add_u32 s60, s60, s56
    buffer_load_dwordx4 v2, s[24:27], s60 offen lds
    s_mul_i32 s61, s59, 196608
    buffer_load_dwordx4 v3, s[24:27], s60 offen offset:1024 lds
    s_add_u32 s61, s61, s66
    buffer_load_dwordx4 v4, s[24:27], s60 offen offset:2048 lds
    buffer_load_dwordx4 v5, s[24:27], s60 offen offset:3072 lds
    s_add_u32 m0, s67, 81920
    s_nop 0
    buffer_load_dwordx4 v10, s[28:31], s61 offen lds
    buffer_load_dwordx4 v11, s[28:31], s61 offen offset:1024 lds
    buffer_load_dwordx4 v6, s[28:31], s61 offen offset:2048 lds
    buffer_load_dwordx4 v7, s[28:31], s61 offen offset:3072 lds
    s_waitcnt vmcnt(9)
    s_barrier
    s_add_u32 s59, s55, 3
    s_and_b32 s59, s59, 7
    s_lshl_b32 s60, s59, 7
    s_add_u32 m0, s67, 98304
    s_add_u32 s60, s60, s56
    buffer_load_dwordx4 v2, s[24:27], s60 offen lds
    s_mul_i32 s61, s59, 196608
    buffer_load_dwordx4 v3, s[24:27], s60 offen offset:1024 lds
    s_add_u32 s61, s61, s66
    buffer_load_dwordx4 v4, s[24:27], s60 offen offset:2048 lds
    buffer_load_dwordx4 v5, s[24:27], s60 offen offset:3072 lds
    s_add_u32 m0, s67, 114688
    s_nop 0
    buffer_load_dwordx4 v10, s[28:31], s61 offen lds
    buffer_load_dwordx4 v11, s[28:31], s61 offen offset:1024 lds
    buffer_load_dwordx4 v6, s[28:31], s61 offen offset:2048 lds
    buffer_load_dwordx4 v7, s[28:31], s61 offen offset:3072 lds
    s_add_u32 s60, s69, 139264
    v_add_u32 v20, s60, v19
    v_lshl_add_u32 v21, v1, 2, s60
    v_and_b32 v28, 31, v1

    v_lshl_add_u32 v12, v28, 6, s60
    v_bfe_u32 v25, v1, 1, 2
    v_lshl_add_u32 v12, v8, 3, v12
    v_lshl_add_u32 v12, v25, 4, v12
    v_xor_b32 v13, 32, v12
    v_xor_b32 v16, 16, v12
    v_xor_b32 v18, 48, v12
    v_lshrrev_b32 v29, 2, v1
    v_lshl_add_u32 v14, v29, 6, s60
    v_bfe_u32 v25, v1, 3, 2
    v_xor_b32 v25, v25, v24
    v_lshl_add_u32 v14, v25, 4, v14
    v_lshlrev_b32 v15, 10, v29
    v_lshl_add_u32 v15, v24, 4, v15
    v_lshrrev_b32 v29, 2, v1
    v_lshlrev_b32 v22, 6, v29
    v_lshl_add_u32 v22, v24, 4, v22
    s_lshl_b32 s60, s58, 10
    s_add_u32 s60, s60, 135168
    v_lshl_add_u32 v23, v1, 3, s60
    v_lshlrev_b32 v28, 2, v28
    s_lshl_b32 s60, s58, 13
    v_add_u32 v24, s60, v19
    v_xor_b32 v25, 0x2000, v24
    s_add_u32 s60, s67, 147456
    v_lshl_add_u32 v29, v1, 3, s60
    v_xor_b32 v17, 0x2000, v29

    s_lshl_b32 s60, s48, 1
    s_lshr_b32 s59, s58, 1
    s_add_u32 s60, s60, s59
    s_lshl_b32 s8, s60, 7
    s_add_u32 s8, s8, 262144
    s_lshl_b32 s9, s60, 10
    s_add_u32 s9, s9, 196608
    s_and_b32 s59, s49, 3
    s_mul_i32 s59, s59, 256
    s_add_u32 s9, s9, s59
    s_lshl_b32 s10, s60, 15
    s_lshl_b32 s59, s49, 7
    s_add_u32 s10, s10, s59
    s_and_b32 s59, s58, 1
    s_lshl_b32 s59, s59, 6
    s_add_u32 s10, s10, s59
    s_add_u32 s11, s10, 16384

    s_waitcnt vmcnt(8)
    s_barrier
    s_add_u32 s59, s55, 4
    s_and_b32 s59, s59, 7
    s_lshl_b32 s60, s59, 7
    s_add_u32 m0, s67, 0
    s_add_u32 s60, s60, s56
    buffer_load_dwordx4 v2, s[24:27], s60 offen lds
    s_mul_i32 s61, s59, 196608
    buffer_load_dwordx4 v3, s[24:27], s60 offen offset:1024 lds
    s_add_u32 s61, s61, s66
    buffer_load_dwordx4 v4, s[24:27], s60 offen offset:2048 lds
    buffer_load_dwordx4 v5, s[24:27], s60 offen offset:3072 lds
    s_add_u32 m0, s67, 16384
    s_nop 0
    buffer_load_dwordx4 v10, s[28:31], s61 offen lds
    buffer_load_dwordx4 v11, s[28:31], s61 offen offset:1024 lds
    buffer_load_dwordx4 v6, s[28:31], s61 offen offset:2048 lds
    buffer_load_dwordx4 v7, s[28:31], s61 offen offset:3072 lds
    s_waitcnt vmcnt(8)
    s_barrier
    s_add_u32 s59, s55, 5
    s_and_b32 s59, s59, 7
    s_lshl_b32 s60, s59, 7
    s_add_u32 m0, s67, 32768
    s_add_u32 s60, s60, s56
    buffer_load_dwordx4 v2, s[24:27], s60 offen lds
    s_mul_i32 s61, s59, 196608
    buffer_load_dwordx4 v3, s[24:27], s60 offen offset:1024 lds
    s_add_u32 s61, s61, s66
    buffer_load_dwordx4 v4, s[24:27], s60 offen offset:2048 lds
    buffer_load_dwordx4 v5, s[24:27], s60 offen offset:3072 lds
    s_add_u32 m0, s67, 49152
    s_nop 0
    buffer_load_dwordx4 v10, s[28:31], s61 offen lds
    buffer_load_dwordx4 v11, s[28:31], s61 offen offset:1024 lds
    buffer_load_dwordx4 v6, s[28:31], s61 offen offset:2048 lds
    buffer_load_dwordx4 v7, s[28:31], s61 offen offset:3072 lds
    s_waitcnt vmcnt(8)
    s_barrier
    s_add_u32 s59, s55, 6
    s_and_b32 s59, s59, 7
    s_lshl_b32 s60, s59, 7
    s_add_u32 m0, s67, 65536
    s_add_u32 s60, s60, s56
    buffer_load_dwordx4 v2, s[24:27], s60 offen lds
    s_mul_i32 s61, s59, 196608
    buffer_load_dwordx4 v3, s[24:27], s60 offen offset:1024 lds
    s_add_u32 s61, s61, s66
    buffer_load_dwordx4 v4, s[24:27], s60 offen offset:2048 lds
    buffer_load_dwordx4 v5, s[24:27], s60 offen offset:3072 lds
    s_add_u32 m0, s67, 81920
    s_nop 0
    buffer_load_dwordx4 v10, s[28:31], s61 offen lds
    buffer_load_dwordx4 v11, s[28:31], s61 offen offset:1024 lds
    buffer_load_dwordx4 v6, s[28:31], s61 offen offset:2048 lds
    buffer_load_dwordx4 v7, s[28:31], s61 offen offset:3072 lds
    s_waitcnt vmcnt(8)
    s_barrier
    s_add_u32 s59, s55, 7
    s_and_b32 s59, s59, 7
    s_lshl_b32 s60, s59, 7
    s_add_u32 m0, s67, 98304
    s_add_u32 s60, s60, s56
    buffer_load_dwordx4 v2, s[24:27], s60 offen lds
    s_mul_i32 s61, s59, 196608
    buffer_load_dwordx4 v3, s[24:27], s60 offen offset:1024 lds
    s_add_u32 s61, s61, s66
    buffer_load_dwordx4 v4, s[24:27], s60 offen offset:2048 lds
    buffer_load_dwordx4 v5, s[24:27], s60 offen offset:3072 lds
    s_add_u32 m0, s67, 114688
    s_nop 0
    buffer_load_dwordx4 v10, s[28:31], s61 offen lds
    buffer_load_dwordx4 v11, s[28:31], s61 offen offset:1024 lds
    buffer_load_dwordx4 v6, s[28:31], s61 offen offset:2048 lds
    buffer_load_dwordx4 v7, s[28:31], s61 offen offset:3072 lds
    s_waitcnt vmcnt(8)
    s_barrier
    s_load_dword s65, s[20:21], 0
    s_add_u32 s59, s68, 0
    s_and_b32 s59, s59, 3
    s_add_u32 s61, s59, s55
    s_and_b32 s61, s61, 7
    s_mul_i32 s61, s61, 196608
    s_lshl_b32 s59, s59, 13
    s_add_u32 s59, s59, s69
    s_add_u32 m0, s59, 0
    s_add_u32 s61, s61, s66
    buffer_load_dwordx4 v26, s[28:31], s61 offen lds
    buffer_load_dwordx4 v27, s[28:31], s61 offen offset:1024 lds
    s_add_u32 s59, s68, 1
    s_and_b32 s59, s59, 3
    s_add_u32 s61, s59, s55
    s_and_b32 s61, s61, 7
    s_mul_i32 s61, s61, 196608
    s_lshl_b32 s59, s59, 13
    s_add_u32 s59, s59, s69
    s_add_u32 m0, s59, 0
    s_add_u32 s61, s61, s66
    buffer_load_dwordx4 v26, s[28:31], s61 offen lds
    buffer_load_dwordx4 v27, s[28:31], s61 offen offset:1024 lds
    s_add_u32 s59, s68, 2
    s_and_b32 s59, s59, 3
    s_add_u32 s61, s59, s55
    s_and_b32 s61, s61, 7
    s_mul_i32 s61, s61, 196608
    s_lshl_b32 s59, s59, 13
    s_add_u32 s59, s59, s69
    s_add_u32 m0, s59, 0
    s_add_u32 s61, s61, s66
    buffer_load_dwordx4 v26, s[28:31], s61 offen lds
    buffer_load_dwordx4 v27, s[28:31], s61 offen offset:1024 lds
    s_add_u32 s59, s68, 3
    s_and_b32 s59, s59, 3
    s_add_u32 s61, s59, s55
    s_and_b32 s61, s61, 7
    s_mul_i32 s61, s61, 196608
    s_lshl_b32 s59, s59, 13
    s_add_u32 s59, s59, s69
    s_add_u32 m0, s59, 0
    s_add_u32 s61, s61, s66
    buffer_load_dwordx4 v26, s[28:31], s61 offen lds
    buffer_load_dwordx4 v27, s[28:31], s61 offen offset:1024 lds
    s_waitcnt vmcnt(8)
    s_barrier
    buffer_load_dwordx4 v[48:51], v19, s[24:27], s6 offen
    buffer_load_dwordx4 v[52:55], v19, s[24:27], s6 offen offset:1024
    s_add_u32 s59, s68, 0
    s_and_b32 s59, s59, 3
    s_add_u32 s61, s59, s55
    s_add_u32 s61, s61, 4
    s_and_b32 s61, s61, 7
    s_mul_i32 s61, s61, 196608
    s_lshl_b32 s59, s59, 13
    s_add_u32 s59, s59, s69
    s_add_u32 m0, s59, 32768
    s_add_u32 s61, s61, s66
    buffer_load_dwordx4 v26, s[28:31], s61 offen lds
    buffer_load_dwordx4 v27, s[28:31], s61 offen offset:1024 lds
    s_add_u32 s59, s68, 1
    s_and_b32 s59, s59, 3
    s_add_u32 s61, s59, s55
    s_add_u32 s61, s61, 4
    s_and_b32 s61, s61, 7
    s_mul_i32 s61, s61, 196608
    s_lshl_b32 s59, s59, 13
    s_add_u32 s59, s59, s69
    s_add_u32 m0, s59, 32768
    s_add_u32 s61, s61, s66
    buffer_load_dwordx4 v26, s[28:31], s61 offen lds
    buffer_load_dwordx4 v27, s[28:31], s61 offen offset:1024 lds
    s_add_u32 s59, s68, 2
    s_and_b32 s59, s59, 3
    s_add_u32 s61, s59, s55
    s_add_u32 s61, s61, 4
    s_and_b32 s61, s61, 7
    s_mul_i32 s61, s61, 196608
    s_lshl_b32 s59, s59, 13
    s_add_u32 s59, s59, s69
    s_add_u32 m0, s59, 32768
    s_add_u32 s61, s61, s66
    buffer_load_dwordx4 v26, s[28:31], s61 offen lds
    buffer_load_dwordx4 v27, s[28:31], s61 offen offset:1024 lds
    s_add_u32 s59, s68, 3
    s_and_b32 s59, s59, 3
    s_add_u32 s61, s59, s55
    s_add_u32 s61, s61, 4
    s_and_b32 s61, s61, 7
    s_mul_i32 s61, s61, 196608
    s_lshl_b32 s59, s59, 13
    s_add_u32 s59, s59, s69
    s_add_u32 m0, s59, 32768
    s_add_u32 s61, s61, s66
    buffer_load_dwordx4 v26, s[28:31], s61 offen lds
    buffer_load_dwordx4 v27, s[28:31], s61 offen offset:1024 lds
    s_mov_b32 s62, 0
Lad_top:
    ds_read_b32 v63, v30 offset:12
    s_waitcnt lgkmcnt(0)
    v_cmp_gt_u32 vcc, 4, v63
    s_cbranch_vccz Lad_done
    s_sleep 1
    s_add_u32 s62, s62, 1
    s_cmp_lt_u32 s62, 1600000
    s_cbranch_scc1 Lad_top
Lad_done:
    s_add_u32 s61, s50, 0
    s_and_b32 s61, s61, 7
    s_lshl_b32 s61, s61, 16
    s_add_u32 m0, s15, 0
    s_add_u32 s61, s61, s14
    buffer_load_dwordx4 v56, s[32:35], s61 offen lds
    buffer_load_dwordx4 v57, s[32:35], s61 offen offset:1024 lds
    buffer_load_dwordx4 v58, s[32:35], s61 offen offset:2048 lds
    buffer_load_dwordx4 v59, s[32:35], s61 offen offset:3072 lds

    s_cmp_ge_u32 s65, 64
    s_cbranch_scc0 Lzc
Lzc_done:

    s_waitcnt vmcnt(12)
    v_dot2c_f32_bf16 v44, v48, v40
    v_dot2c_f32_bf16 v45, v52, v40
    v_dot2c_f32_bf16 v44, v49, v41
    v_dot2c_f32_bf16 v45, v53, v41
    v_dot2c_f32_bf16 v44, v50, v42
    v_dot2c_f32_bf16 v45, v54, v42
    v_dot2c_f32_bf16 v44, v51, v43
    v_dot2c_f32_bf16 v45, v55, v43

    s_nop 2
    v_permlane32_swap_b32 v44, v45
    s_nop 1
    v_add_f32 v44, v44, v45
    s_nop 1
    v_add_f32_dpp v44, v44, v44 row_ror:8 row_mask:0xf bank_mask:0xf
    s_nop 1
    v_add_f32_dpp v44, v44, v44 row_ror:4 row_mask:0xf bank_mask:0xf
    s_nop 1
    v_add_f32_dpp v44, v44, v44 row_ror:2 row_mask:0xf bank_mask:0xf
    s_nop 1
    v_add_f32_dpp v44, v44, v44 row_ror:1 row_mask:0xf bank_mask:0xf
    v_mov_b32 v45, v44
    s_nop 1
    v_permlane16_swap_b32 v44, v45
    s_nop 1
    v_add_f32 v44, v44, v45
    v_cvt_pk_bf16_f32 v44, v44, v44
    v_and_b32 v44, 0xffff0000, v44
    v_mul_f32 v44, 0xbfb8aa3b, v44
    v_exp_f32 v44, v44
    v_lshlrev_b32 v45, 2, v8
    v_add_f32 v44, 1.0, v44
    v_rcp_f32 v44, v44
    s_nop 0
    v_cvt_pk_bf16_f32 v44, v44, v44
    v_and_b32 v44, 0xffff0000, v44

    s_waitcnt vmcnt(4)
    s_mov_b64 exec, 1
    ds_add_u32 v30, v31 offset:0
    s_mov_b64 exec, -1
    s_setprio 2
    v_lshlrev_b32 v37, 2, v1
    s_and_b32 s59, s52, 1
    s_lshl_b32 s59, s59, 9
    s_add_u32 s59, s59, s12
    s_mov_b32 s62, 0
Lkp_top:
    ds_read_b32 v36, v21 offset:1024
    ds_read_b32 v32, v21
    ds_read_b32 v33, v21 offset:256
    s_waitcnt lgkmcnt(0)
    v_cmp_eq_u32 vcc, 0, v36
    s_cbranch_vccz Lkp_done
    s_sleep 1
    s_add_u32 s62, s62, 1
    s_cmp_lt_u32 s62, 1600000
    s_cbranch_scc1 Lkp_top
Lkp_done:
    buffer_atomic_pk_add_bf16 v32, v37, s[40:43], s59 offen offset:0
    buffer_atomic_pk_add_bf16 v33, v37, s[40:43], s59 offen offset:256

    s_mov_b64 exec, 0xffff
    s_add_u32 s3, s3, 1024
    buffer_atomic_add_f32 v36, v9, s[40:43], s3 offen
    s_mov_b32 exec_lo, 1
    s_mov_b32 exec_hi, 1
    buffer_store_dword v44, v45, s[40:43], s7 offen sc1
    s_mov_b64 exec, -1
    s_mov_b32 s65, 1
    s_mov_b32 s64, 16
    v_lshlrev_b32 v38, 3, v1

    s_add_u32 s61, s50, 0
    s_and_b32 s61, s61, 7
    s_lshl_b32 s61, s61, 16
    s_add_u32 m0, s15, 4096
    s_add_u32 s61, s61, s14
    s_add_u32 s61, s61, 32768
    buffer_load_dwordx4 v56, s[32:35], s61 offen lds
    buffer_load_dwordx4 v57, s[32:35], s61 offen offset:1024 lds
    buffer_load_dwordx4 v58, s[32:35], s61 offen offset:2048 lds
    buffer_load_dwordx4 v59, s[32:35], s61 offen offset:3072 lds
    s_waitcnt vmcnt(5)
    s_xor_b32 s59, s13, 256
    s_atomic_add s51, s[22:23], s59
    s_xor_b32 s59, s13, 512
    s_atomic_add s51, s[22:23], s59
    s_xor_b32 s59, s13, 768
    s_atomic_add s51, s[22:23], s59
    s_atomic_add s65, s[22:23], s13 glc
    s_add_u32 s61, s50, 2
    s_and_b32 s61, s61, 7
    s_lshl_b32 s61, s61, 16
    s_add_u32 m0, s15, 8192
    s_add_u32 s61, s61, s14
    buffer_load_dwordx4 v56, s[32:35], s61 offen lds
    buffer_load_dwordx4 v57, s[32:35], s61 offen offset:1024 lds
    buffer_load_dwordx4 v58, s[32:35], s61 offen offset:2048 lds
    buffer_load_dwordx4 v59, s[32:35], s61 offen offset:3072 lds
    s_add_u32 m0, s15, 12288
    s_add_u32 s61, s61, 32768
    buffer_load_dwordx4 v56, s[32:35], s61 offen lds
    buffer_load_dwordx4 v57, s[32:35], s61 offen offset:1024 lds
    buffer_load_dwordx4 v58, s[32:35], s61 offen offset:2048 lds
    buffer_load_dwordx4 v59, s[32:35], s61 offen offset:3072 lds
    s_waitcnt lgkmcnt(0)
    s_add_u32 s65, s65, 1
    s_cmp_eq_u32 s64, -1
    s_cbranch_scc1 Lkv_have
    s_cmp_eq_u32 s65, 16
    s_cbranch_scc1 Lpollkv_done
    s_mov_b32 s62, 0
Lpollkv_top:
    s_load_dword s65, s[22:23], s13 glc
    s_waitcnt lgkmcnt(0)
    s_cmp_eq_u32 s65, 16
    s_cbranch_scc1 Lpollkv_done
    s_sleep 1
    s_add_u32 s62, s62, 1
    s_cmp_lt_u32 s62, 200000
    s_cbranch_scc1 Lpollkv_top
Lpollkv_done:
    buffer_load_dwordx2 v[32:33], v38, s[40:43], s12 offen sc1
    buffer_load_dwordx2 v[66:67], v38, s[40:43], s12 offen offset:512 sc1
    s_mov_b64 exec, 0xf
    buffer_load_dwordx4 v[40:43], v22, s[40:43], s3 offen sc1
    s_mov_b64 exec, -1
    s_mov_b32 s64, -1
    s_waitcnt vmcnt(0)
    v_lshlrev_b32 v48, 16, v32
    v_and_b32 v49, 0xffff0000, v32
    v_lshlrev_b32 v50, 16, v66
    v_and_b32 v51, 0xffff0000, v66
    v_add_f32 v48, v48, v50
    v_add_f32 v49, v49, v51
    v_cvt_pk_bf16_f32 v32, v48, v49
    v_lshlrev_b32 v48, 16, v33
    v_and_b32 v49, 0xffff0000, v33
    v_lshlrev_b32 v50, 16, v67
    v_and_b32 v51, 0xffff0000, v67
    v_add_f32 v48, v48, v50
    v_add_f32 v49, v49, v51
    v_cvt_pk_bf16_f32 v33, v48, v49
    ds_write_b64 v23, v[32:33]
    v_cvt_pk_bf16_f32 v34, v40, v41
    v_cvt_pk_bf16_f32 v35, v42, v43
    s_mov_b64 exec, 0xf
    ds_write_b64 v23, v[34:35] offset:512
    s_mov_b64 exec, 1
    ds_add_u32 v30, v31 offset:4
    s_mov_b64 exec, -1
    s_setprio 0
Lkv_have:
    s_mov_b64 exec, 1
    ds_add_u32 v62, v31 offset:0
    s_mov_b64 exec, -1
    s_mov_b32 s62, 0
Lps0_top:
    ds_read_b32 v63, v62
    s_waitcnt lgkmcnt(0)
    v_cmp_gt_u32 vcc, 2, v63
    s_cbranch_vccz Lps0_done
    s_add_u32 s62, s62, 1
    s_cmp_lt_u32 s62, 1600000
    s_cbranch_scc1 Lps0_top
Lps0_done:
    ds_read_b64_tr_b16 v[128:129], v60 offset:0
    ds_read_b64_tr_b16 v[130:131], v60 offset:1024
    ds_read_b64_tr_b16 v[132:133], v61 offset:0
    ds_read_b64_tr_b16 v[134:135], v61 offset:1024
    ds_read_b64_tr_b16 v[136:137], v60 offset:2048
    ds_read_b64_tr_b16 v[138:139], v60 offset:3072
    ds_read_b64_tr_b16 v[140:141], v61 offset:2048
    ds_read_b64_tr_b16 v[142:143], v61 offset:3072
    ds_read_b64_tr_b16 v[144:145], v60 offset:4096
    ds_read_b64_tr_b16 v[146:147], v60 offset:5120
    ds_read_b64_tr_b16 v[148:149], v61 offset:4096
    ds_read_b64_tr_b16 v[150:151], v61 offset:5120
    ds_read_b64_tr_b16 v[152:153], v60 offset:6144
    ds_read_b64_tr_b16 v[154:155], v60 offset:7168
    ds_read_b64_tr_b16 v[156:157], v61 offset:6144
    ds_read_b64_tr_b16 v[158:159], v61 offset:7168
    ds_read_b64_tr_b16 v[160:161], v60 offset:8192
    ds_read_b64_tr_b16 v[162:163], v60 offset:9216
    ds_read_b64_tr_b16 v[164:165], v61 offset:8192
    ds_read_b64_tr_b16 v[166:167], v61 offset:9216
    ds_read_b64_tr_b16 v[168:169], v60 offset:10240
    ds_read_b64_tr_b16 v[170:171], v60 offset:11264
    ds_read_b64_tr_b16 v[172:173], v61 offset:10240
    ds_read_b64_tr_b16 v[174:175], v61 offset:11264
    ds_read_b64_tr_b16 v[176:177], v60 offset:12288
    ds_read_b64_tr_b16 v[178:179], v60 offset:13312
    ds_read_b64_tr_b16 v[180:181], v61 offset:12288
    ds_read_b64_tr_b16 v[182:183], v61 offset:13312
    ds_read_b64_tr_b16 v[184:185], v60 offset:14336
    ds_read_b64_tr_b16 v[186:187], v60 offset:15360
    ds_read_b64_tr_b16 v[188:189], v61 offset:14336
    ds_read_b64_tr_b16 v[190:191], v61 offset:15360
    s_waitcnt lgkmcnt(0)
    s_mov_b64 exec, 1
    ds_add_u32 v62, v31 offset:0
    s_mov_b64 exec, -1
    s_mov_b32 s62, 0
Lps1_top:
    ds_read_b32 v63, v62
    s_waitcnt lgkmcnt(0)
    v_cmp_gt_u32 vcc, 4, v63
    s_cbranch_vccz Lps1_done
    s_add_u32 s62, s62, 1
    s_cmp_lt_u32 s62, 1600000
    s_cbranch_scc1 Lps1_top
Lps1_done:
    s_mov_b32 s62, 0
Lxo_top:
    ds_read_b32 v63, v30 offset:8
    s_waitcnt lgkmcnt(0)
    v_cmp_gt_u32 vcc, 4, v63
    s_cbranch_vccz Lxo_done
    s_sleep 1
    s_add_u32 s62, s62, 1
    s_cmp_lt_u32 s62, 1600000
    s_cbranch_scc1 Lxo_top
Lxo_done:
    s_add_u32 s61, s50, 4
    s_and_b32 s61, s61, 7
    s_lshl_b32 s61, s61, 16
    s_add_u32 m0, s15, 0
    s_add_u32 s61, s61, s14
    buffer_load_dwordx4 v56, s[32:35], s61 offen lds
    buffer_load_dwordx4 v57, s[32:35], s61 offen offset:1024 lds
    buffer_load_dwordx4 v58, s[32:35], s61 offen offset:2048 lds
    buffer_load_dwordx4 v59, s[32:35], s61 offen offset:3072 lds
    s_add_u32 m0, s15, 4096
    s_add_u32 s61, s61, 32768
    buffer_load_dwordx4 v56, s[32:35], s61 offen lds
    buffer_load_dwordx4 v57, s[32:35], s61 offen offset:1024 lds
    buffer_load_dwordx4 v58, s[32:35], s61 offen offset:2048 lds
    buffer_load_dwordx4 v59, s[32:35], s61 offen offset:3072 lds
    s_add_u32 s61, s50, 6
    s_and_b32 s61, s61, 7
    s_lshl_b32 s61, s61, 16
    s_add_u32 m0, s15, 8192
    s_add_u32 s61, s61, s14
    buffer_load_dwordx4 v56, s[32:35], s61 offen lds
    buffer_load_dwordx4 v57, s[32:35], s61 offen offset:1024 lds
    buffer_load_dwordx4 v58, s[32:35], s61 offen offset:2048 lds
    buffer_load_dwordx4 v59, s[32:35], s61 offen offset:3072 lds
    s_add_u32 m0, s15, 12288
    s_add_u32 s61, s61, 32768
    buffer_load_dwordx4 v56, s[32:35], s61 offen lds
    buffer_load_dwordx4 v57, s[32:35], s61 offen offset:1024 lds
    buffer_load_dwordx4 v58, s[32:35], s61 offen offset:2048 lds
    buffer_load_dwordx4 v59, s[32:35], s61 offen offset:3072 lds
    s_waitcnt vmcnt(0)
    s_waitcnt lgkmcnt(0)
    s_barrier
    ds_read_b64_tr_b16 v[192:193], v60 offset:0
    ds_read_b64_tr_b16 v[194:195], v60 offset:1024
    ds_read_b64_tr_b16 v[196:197], v61 offset:0
    ds_read_b64_tr_b16 v[198:199], v61 offset:1024
    ds_read_b64_tr_b16 v[200:201], v60 offset:2048
    ds_read_b64_tr_b16 v[202:203], v60 offset:3072
    ds_read_b64_tr_b16 v[204:205], v61 offset:2048
    ds_read_b64_tr_b16 v[206:207], v61 offset:3072
    ds_read_b64_tr_b16 v[208:209], v60 offset:4096
    ds_read_b64_tr_b16 v[210:211], v60 offset:5120
    ds_read_b64_tr_b16 v[212:213], v61 offset:4096
    ds_read_b64_tr_b16 v[214:215], v61 offset:5120
    ds_read_b64_tr_b16 v[216:217], v60 offset:6144
    ds_read_b64_tr_b16 v[218:219], v60 offset:7168
    ds_read_b64_tr_b16 v[220:221], v61 offset:6144
    ds_read_b64_tr_b16 v[222:223], v61 offset:7168
    ds_read_b64_tr_b16 v[224:225], v60 offset:8192
    ds_read_b64_tr_b16 v[226:227], v60 offset:9216
    ds_read_b64_tr_b16 v[228:229], v61 offset:8192
    ds_read_b64_tr_b16 v[230:231], v61 offset:9216
    ds_read_b64_tr_b16 v[232:233], v60 offset:10240
    ds_read_b64_tr_b16 v[234:235], v60 offset:11264
    ds_read_b64_tr_b16 v[236:237], v61 offset:10240
    ds_read_b64_tr_b16 v[238:239], v61 offset:11264
    ds_read_b64_tr_b16 v[240:241], v60 offset:12288
    ds_read_b64_tr_b16 v[242:243], v60 offset:13312
    ds_read_b64_tr_b16 v[244:245], v61 offset:12288
    ds_read_b64_tr_b16 v[246:247], v61 offset:13312
    ds_read_b64_tr_b16 v[248:249], v60 offset:14336
    ds_read_b64_tr_b16 v[250:251], v60 offset:15360
    ds_read_b64_tr_b16 v[252:253], v61 offset:14336
    ds_read_b64_tr_b16 v[254:255], v61 offset:15360
    buffer_load_dword v2, v28, s[40:43], s8 offen sc1
    v_add_u32 v10, 0x10000, v24
    v_add_u32 v11, 0x10000, v25
    s_waitcnt lgkmcnt(0)
    s_barrier
    ds_read_b128 v[64:67], v24 offset:0
    ds_read_b128 v[68:71], v25 offset:0
    ds_read_b128 v[72:75], v24 offset:1024
    ds_read_b128 v[76:79], v25 offset:1024
    ds_read_b128 v[80:83], v24 offset:2048
    ds_read_b128 v[84:87], v25 offset:2048
    ds_read_b128 v[88:91], v24 offset:3072
    s_waitcnt lgkmcnt(5)
    v_mfma_f32_32x32x16_bf16 v[48:63], v[128:131], v[64:67], 0
    ds_read_b128 v[92:95], v25 offset:3072
    v_mfma_f32_32x32x16_bf16 v[48:63], v[132:135], v[68:71], v[48:63]
    ds_read_b128 v[96:99], v24 offset:4096
    s_waitcnt lgkmcnt(5)
    v_mfma_f32_32x32x16_bf16 v[48:63], v[136:139], v[72:75], v[48:63]
    ds_read_b128 v[100:103], v25 offset:4096
    v_mfma_f32_32x32x16_bf16 v[48:63], v[140:143], v[76:79], v[48:63]
    ds_read_b128 v[104:107], v24 offset:5120
    s_waitcnt lgkmcnt(5)
    v_mfma_f32_32x32x16_bf16 v[48:63], v[144:147], v[80:83], v[48:63]
    ds_read_b128 v[108:111], v25 offset:5120
    v_mfma_f32_32x32x16_bf16 v[48:63], v[148:151], v[84:87], v[48:63]
    ds_read_b128 v[112:115], v24 offset:6144
    s_waitcnt lgkmcnt(5)
    v_mfma_f32_32x32x16_bf16 v[48:63], v[152:155], v[88:91], v[48:63]
    ds_read_b128 v[116:119], v25 offset:6144
    v_mfma_f32_32x32x16_bf16 v[48:63], v[156:159], v[92:95], v[48:63]
    ds_read_b128 v[120:123], v24 offset:7168
    s_waitcnt lgkmcnt(5)
    v_mfma_f32_32x32x16_bf16 v[48:63], v[160:163], v[96:99], v[48:63]
    ds_read_b128 v[124:127], v25 offset:7168
    v_mfma_f32_32x32x16_bf16 v[48:63], v[164:167], v[100:103], v[48:63]
    s_waitcnt lgkmcnt(4)
    v_mfma_f32_32x32x16_bf16 v[48:63], v[168:171], v[104:107], v[48:63]
    v_mfma_f32_32x32x16_bf16 v[48:63], v[172:175], v[108:111], v[48:63]
    s_barrier
    ds_read_b128 v[64:67], v24 offset:32768
    ds_read_b128 v[68:71], v25 offset:32768
    ds_read_b128 v[72:75], v24 offset:33792
    s_waitcnt lgkmcnt(5)
    v_mfma_f32_32x32x16_bf16 v[48:63], v[176:179], v[112:115], v[48:63]
    ds_read_b128 v[76:79], v25 offset:33792
    v_mfma_f32_32x32x16_bf16 v[48:63], v[180:183], v[116:119], v[48:63]
    ds_read_b128 v[80:83], v24 offset:34816
    s_waitcnt lgkmcnt(5)
    v_mfma_f32_32x32x16_bf16 v[48:63], v[184:187], v[120:123], v[48:63]
    ds_read_b128 v[84:87], v25 offset:34816
    v_mfma_f32_32x32x16_bf16 v[48:63], v[188:191], v[124:127], v[48:63]
    ds_read_b128 v[88:91], v24 offset:35840
    s_waitcnt lgkmcnt(5)
    v_mfma_f32_32x32x16_bf16 v[48:63], v[192:195], v[64:67], v[48:63]
    ds_read_b128 v[92:95], v25 offset:35840
    v_mfma_f32_32x32x16_bf16 v[48:63], v[196:199], v[68:71], v[48:63]
    ds_read_b128 v[96:99], v24 offset:36864
    s_waitcnt lgkmcnt(5)
    v_mfma_f32_32x32x16_bf16 v[48:63], v[200:203], v[72:75], v[48:63]
    ds_read_b128 v[100:103], v25 offset:36864
    v_mfma_f32_32x32x16_bf16 v[48:63], v[204:207], v[76:79], v[48:63]
    ds_read_b128 v[104:107], v24 offset:37888
    s_waitcnt lgkmcnt(5)
    v_mfma_f32_32x32x16_bf16 v[48:63], v[208:211], v[80:83], v[48:63]
    ds_read_b128 v[108:111], v25 offset:37888
    v_mfma_f32_32x32x16_bf16 v[48:63], v[212:215], v[84:87], v[48:63]
    ds_read_b128 v[112:115], v24 offset:38912
    s_waitcnt lgkmcnt(5)
    v_mfma_f32_32x32x16_bf16 v[48:63], v[216:219], v[88:91], v[48:63]
    ds_read_b128 v[116:119], v25 offset:38912
    v_mfma_f32_32x32x16_bf16 v[48:63], v[220:223], v[92:95], v[48:63]
    ds_read_b128 v[120:123], v24 offset:39936
    s_waitcnt lgkmcnt(5)
    v_mfma_f32_32x32x16_bf16 v[48:63], v[224:227], v[96:99], v[48:63]
    ds_read_b128 v[124:127], v25 offset:39936
    v_mfma_f32_32x32x16_bf16 v[48:63], v[228:231], v[100:103], v[48:63]
    s_waitcnt lgkmcnt(4)
    v_mfma_f32_32x32x16_bf16 v[48:63], v[232:235], v[104:107], v[48:63]
    v_mfma_f32_32x32x16_bf16 v[48:63], v[236:239], v[108:111], v[48:63]
    s_barrier
    ds_read_b128 v[64:67], v10 offset:0
    ds_read_b128 v[68:71], v11 offset:0
    ds_read_b128 v[72:75], v10 offset:1024
    s_waitcnt lgkmcnt(5)
    v_mfma_f32_32x32x16_bf16 v[48:63], v[240:243], v[112:115], v[48:63]
    ds_read_b128 v[76:79], v11 offset:1024
    v_mfma_f32_32x32x16_bf16 v[48:63], v[244:247], v[116:119], v[48:63]
    ds_read_b128 v[80:83], v10 offset:2048
    s_waitcnt lgkmcnt(5)
    v_mfma_f32_32x32x16_bf16 v[48:63], v[248:251], v[120:123], v[48:63]
    ds_read_b128 v[84:87], v11 offset:2048
    v_mfma_f32_32x32x16_bf16 v[48:63], v[252:255], v[124:127], v[48:63]
    ds_read_b128 v[88:91], v10 offset:3072
    s_waitcnt lgkmcnt(5)
    v_mfma_f32_32x32x16_bf16 v[32:47], v[128:131], v[64:67], 0
    ds_read_b128 v[92:95], v11 offset:3072
    v_mfma_f32_32x32x16_bf16 v[32:47], v[132:135], v[68:71], v[32:47]
    ds_read_b128 v[96:99], v10 offset:4096
    s_waitcnt lgkmcnt(5)
    v_mfma_f32_32x32x16_bf16 v[32:47], v[136:139], v[72:75], v[32:47]
    ds_read_b128 v[100:103], v11 offset:4096
    v_mfma_f32_32x32x16_bf16 v[32:47], v[140:143], v[76:79], v[32:47]
    s_nop 1
    ds_write_b64 v29, v[48:49] offset:0
    ds_read_b128 v[104:107], v10 offset:5120
    s_waitcnt lgkmcnt(6)
    v_mfma_f32_32x32x16_bf16 v[32:47], v[144:147], v[80:83], v[32:47]
    ds_write_b64 v29, v[50:51] offset:512
    ds_read_b128 v[108:111], v11 offset:5120
    v_mfma_f32_32x32x16_bf16 v[32:47], v[148:151], v[84:87], v[32:47]
    ds_write_b64 v29, v[52:53] offset:1024
    ds_read_b128 v[112:115], v10 offset:6144
    s_waitcnt lgkmcnt(8)
    v_mfma_f32_32x32x16_bf16 v[32:47], v[152:155], v[88:91], v[32:47]
    ds_write_b64 v29, v[54:55] offset:1536
    ds_read_b128 v[116:119], v11 offset:6144
    v_mfma_f32_32x32x16_bf16 v[32:47], v[156:159], v[92:95], v[32:47]
    ds_write_b64 v29, v[56:57] offset:2048
    ds_read_b128 v[120:123], v10 offset:7168
    s_waitcnt lgkmcnt(10)
    v_mfma_f32_32x32x16_bf16 v[32:47], v[160:163], v[96:99], v[32:47]
    ds_write_b64 v29, v[58:59] offset:2560
    ds_read_b128 v[124:127], v11 offset:7168
    v_mfma_f32_32x32x16_bf16 v[32:47], v[164:167], v[100:103], v[32:47]
    ds_write_b64 v29, v[60:61] offset:3072
    s_waitcnt lgkmcnt(9)
    v_mfma_f32_32x32x16_bf16 v[32:47], v[168:171], v[104:107], v[32:47]
    ds_write_b64 v29, v[62:63] offset:3584
    v_mfma_f32_32x32x16_bf16 v[32:47], v[172:175], v[108:111], v[32:47]
    s_waitcnt lgkmcnt(0)
    s_barrier
    ds_read_b128 v[64:67], v10 offset:32768
    ds_read_b128 v[68:71], v11 offset:32768
    ds_read_b128 v[72:75], v10 offset:33792
    s_waitcnt lgkmcnt(9)
    v_mfma_f32_32x32x16_bf16 v[32:47], v[176:179], v[112:115], v[32:47]
    ds_read_b128 v[76:79], v11 offset:33792
    v_mfma_f32_32x32x16_bf16 v[32:47], v[180:183], v[116:119], v[32:47]
    ds_read_b64 v[48:49], v17 offset:0
    ds_read_b128 v[80:83], v10 offset:34816
    s_waitcnt lgkmcnt(8)
    v_mfma_f32_32x32x16_bf16 v[32:47], v[184:187], v[120:123], v[32:47]
    ds_read_b64 v[50:51], v17 offset:512
    ds_read_b128 v[84:87], v11 offset:34816
    v_mfma_f32_32x32x16_bf16 v[32:47], v[188:191], v[124:127], v[32:47]
    ds_read_b64 v[52:53], v17 offset:1024
    ds_read_b128 v[88:91], v10 offset:35840
    s_waitcnt lgkmcnt(8)
    v_mfma_f32_32x32x16_bf16 v[32:47], v[192:195], v[64:67], v[32:47]
    ds_read_b64 v[54:55], v17 offset:1536
    ds_read_b128 v[92:95], v11 offset:35840
    v_mfma_f32_32x32x16_bf16 v[32:47], v[196:199], v[68:71], v[32:47]
    ds_read_b64 v[56:57], v17 offset:2048
    ds_read_b128 v[96:99], v10 offset:36864
    s_waitcnt lgkmcnt(10)
    v_mfma_f32_32x32x16_bf16 v[32:47], v[200:203], v[72:75], v[32:47]
    ds_read_b64 v[58:59], v17 offset:2560
    ds_read_b128 v[100:103], v11 offset:36864
    v_mfma_f32_32x32x16_bf16 v[32:47], v[204:207], v[76:79], v[32:47]
    ds_read_b64 v[60:61], v17 offset:3072
    ds_read_b128 v[104:107], v10 offset:37888
    s_waitcnt lgkmcnt(10)
    v_mfma_f32_32x32x16_bf16 v[32:47], v[208:211], v[80:83], v[32:47]
    ds_read_b64 v[62:63], v17 offset:3584
    ds_read_b128 v[108:111], v11 offset:37888
    v_mfma_f32_32x32x16_bf16 v[32:47], v[212:215], v[84:87], v[32:47]
    s_waitcnt vmcnt(0)
    ds_read_b128 v[112:115], v10 offset:38912
    s_waitcnt lgkmcnt(9)
    v_mfma_f32_32x32x16_bf16 v[32:47], v[216:219], v[88:91], v[32:47]
    v_sub_f32 v4, 1.0, v2
    v_cvt_pk_bf16_f32 v4, v4, v4
    v_and_b32 v4, 0xffff0000, v4
    ds_read_b128 v[116:119], v11 offset:38912
    v_mfma_f32_32x32x16_bf16 v[32:47], v[220:223], v[92:95], v[32:47]
    s_cmp_ge_u32 s58, 2
    s_cselect_b64 vcc, -1, 0
    ds_read_b128 v[120:123], v10 offset:39936
    s_waitcnt lgkmcnt(7)
    v_mfma_f32_32x32x16_bf16 v[32:47], v[224:227], v[96:99], v[32:47]
    v_cndmask_b32 v6, v2, v4, vcc
    ds_read_b128 v[124:127], v11 offset:39936
    v_mfma_f32_32x32x16_bf16 v[32:47], v[228:231], v[100:103], v[32:47]
    v_cndmask_b32 v4, v4, v2, vcc
    s_waitcnt lgkmcnt(4)
    v_mfma_f32_32x32x16_bf16 v[32:47], v[232:235], v[104:107], v[32:47]
    v_mfma_f32_32x32x16_bf16 v[32:47], v[236:239], v[108:111], v[32:47]
    s_waitcnt lgkmcnt(2)
    v_mfma_f32_32x32x16_bf16 v[32:47], v[240:243], v[112:115], v[32:47]
    v_mul_f32 v48, v48, v4
    v_mul_f32 v49, v49, v4
    v_mul_f32 v50, v50, v4
    v_mul_f32 v51, v51, v4
    v_mfma_f32_32x32x16_bf16 v[32:47], v[244:247], v[116:119], v[32:47]
    v_mul_f32 v52, v52, v4
    v_mul_f32 v53, v53, v4
    v_mul_f32 v54, v54, v4
    v_mul_f32 v55, v55, v4
    s_waitcnt lgkmcnt(0)
    v_mfma_f32_32x32x16_bf16 v[32:47], v[248:251], v[120:123], v[32:47]
    v_mul_f32 v56, v56, v4
    v_mul_f32 v57, v57, v4
    v_mul_f32 v58, v58, v4
    v_mul_f32 v59, v59, v4
    v_mfma_f32_32x32x16_bf16 v[32:47], v[252:255], v[124:127], v[32:47]
    v_mul_f32 v60, v60, v4
    v_mul_f32 v61, v61, v4
    v_mul_f32 v62, v62, v4
    v_mul_f32 v63, v63, v4
    s_nop 7
    v_pk_fma_f32 v[32:33], v[32:33], v[6:7], v[48:49] op_sel_hi:[1,0,1]
    v_pk_fma_f32 v[34:35], v[34:35], v[6:7], v[50:51] op_sel_hi:[1,0,1]
    v_cvt_pk_bf16_f32 v32, v32, v33
    v_cvt_pk_bf16_f32 v33, v34, v35
    ds_write_b64 v12, v[32:33]
    v_pk_fma_f32 v[36:37], v[36:37], v[6:7], v[52:53] op_sel_hi:[1,0,1]
    v_pk_fma_f32 v[38:39], v[38:39], v[6:7], v[54:55] op_sel_hi:[1,0,1]
    v_cvt_pk_bf16_f32 v36, v36, v37
    v_cvt_pk_bf16_f32 v37, v38, v39
    ds_write_b64 v16, v[36:37]
    v_pk_fma_f32 v[40:41], v[40:41], v[6:7], v[56:57] op_sel_hi:[1,0,1]
    v_pk_fma_f32 v[42:43], v[42:43], v[6:7], v[58:59] op_sel_hi:[1,0,1]
    v_cvt_pk_bf16_f32 v40, v40, v41
    v_cvt_pk_bf16_f32 v41, v42, v43
    ds_write_b64 v13, v[40:41]
    v_pk_fma_f32 v[44:45], v[44:45], v[6:7], v[60:61] op_sel_hi:[1,0,1]
    v_pk_fma_f32 v[46:47], v[46:47], v[6:7], v[62:63] op_sel_hi:[1,0,1]
    v_cvt_pk_bf16_f32 v44, v44, v45
    v_cvt_pk_bf16_f32 v45, v46, v47
    ds_write_b64 v18, v[44:45]

    ds_read_b128 v[64:67], v14
    ds_read_b128 v[68:71], v14 offset:1024
    s_waitcnt lgkmcnt(1)
    buffer_store_dwordx4 v[64:67], v15, s[44:47], s10 offen sc1
    s_waitcnt lgkmcnt(0)
    buffer_store_dwordx4 v[68:71], v15, s[44:47], s11 offen sc1

    s_endpgm
Lx:

    s_load_dwordx16 s[4:19], s[0:1], 0
    s_load_dwordx4 s[20:23], s[0:1], 64
    s_and_b32 s62, s2, 7
    s_lshl2_add_u32 s48, s62, s3
    s_lshr_b32 s53, s62, 1
    s_lshl2_add_u32 s53, s53, s3
    s_and_b32 s50, s58, 1
    s_lshl1_add_u32 s50, s3, s50
    s_mov_b32 s51, 1

    s_getpc_b64 s[66:67]
Lpc0:
    s_sub_u32 s66, s66, Lpc0-gated_mix__linear_attn_block__linear_attn_block__prompt_kernel
    s_subb_u32 s67, s67, 0
    s_and_b32 s59, s49, 3
    s_lshl_b32 s59, s59, 2
    s_add_u32 s59, s59, s58
    s_lshl_b32 s59, s59, 10
    v_lshl_add_u32 v140, v1, 7, s59
    v_min_u32 v140, Lcode_end-gated_mix__linear_attn_block__linear_attn_block__prompt_kernel-4, v140
    s_mov_b64 exec, 0xff
    global_load_dword v252, v140, s[66:67]
    s_mov_b64 exec, -1
    v_lshlrev_b32 v14, 4, v1
    v_mov_b32 v240, 0
    v_mov_b32 v241, 0
    v_mov_b32 v242, 0
    v_mov_b32 v243, 0
    v_mov_b32 v12, 131072
    v_mov_b32 v13, 1
    s_lshl_b32 s60, s58, 11
    s_add_u32 s60, s60, 139264
    v_add_u32 v5, s60, v14
    v_lshl_add_u32 v15, v1, 2, s60
    ds_write_b128 v12, v[240:243]
    ds_write_b32 v15, v240 offset:1024
    ds_write_b128 v12, v[240:243] offset:16
    ds_write_b128 v12, v[240:243] offset:32
    v_and_b32 v23, 3, v1
    s_mov_b32 s42, 6291456
    s_mov_b32 s43, 0x20000
    s_cmp_eq_u32 s52, s53
    s_waitcnt lgkmcnt(0)
    s_mov_b32 s40, s22
    s_mov_b32 s41, s23
    s_cbranch_scc0 Lnozero
    s_lshl_b32 s59, s53, 2
    s_add_u32 s59, s59, s58
    s_mul_i32 s60, s59, 1152
    s_add_u32 s60, s60, 5242880

    buffer_store_dwordx4 v[240:243], v14, s[40:43], s60 offen sc1

    s_add_u32 s60, s60, 1024
    s_lshl_b32 s61, s59, 10
    s_add_u32 s62, s61, 196608
    s_add_u32 s61, s61, 131072
    buffer_store_dwordx4 v[240:243], v14, s[40:43], s61 offen sc1
    buffer_store_dwordx4 v[240:243], v14, s[40:43], s62 offen sc1
    s_mov_b64 exec, 0xff
    buffer_store_dwordx4 v[240:243], v14, s[40:43], s60 offen sc1

    s_lshl_b32 s61, s59, 7
    s_add_u32 s61, s61, 262144
    buffer_store_dwordx4 v[240:243], v14, s[40:43], s61 offen sc1
    s_mov_b64 exec, -1
Lnozero:
    s_mov_b32 s36, 0x3fb8aa3b
    s_mov_b32 s37, 0x3fb8aa3b
    s_mov_b32 s38, 0x358637bd
    s_mov_b32 s39, 0x358637bd
    v_and_b32 v20, 15, v1
    v_lshrrev_b32 v21, 4, v1
    v_lshrrev_b32 v22, 1, v20
    v_xor_b32 v22, v21, v22
    v_lshlrev_b32 v2, 7, v20
    v_lshl_add_u32 v2, v22, 4, v2
    v_xor_b32 v3, 64, v2
    v_lshrrev_b32 v24, 5, v1
    v_lshlrev_b32 v4, 12, v24
    v_and_b32 v25, 1, v21
    v_lshl_add_u32 v4, v25, 10, v4
    v_lshrrev_b32 v26, 2, v20
    v_lshl_add_u32 v4, v26, 7, v4
    v_bfe_u32 v22, v1, 3, 2
    v_xor_b32 v22, s58, v22
    v_lshl_add_u32 v4, v22, 5, v4
    v_lshl_add_u32 v4, v23, 3, v4
    v_add_u32 v4, 16384, v4
    s_lshl_b32 s60, s58, 11
    s_add_u32 s60, s60, 139264
    v_lshl_add_u32 v5, v20, 5, s60
    v_lshl_add_u32 v5, v25, 4, v5
    v_lshl_add_u32 v5, v24, 3, v5
    v_bfe_u32 v22, v1, 3, 1
    v_lshl_add_u32 v10, v24, 3, v26
    v_lshlrev_b32 v10, 7, v10
    v_lshl_add_u32 v10, v25, 5, v10
    v_lshl_add_u32 v10, v23, 3, v10
    v_lshl_add_u32 v10, v22, 6, v10
    v_xor_b32 v11, 64, v10
    v_and_b32 v20, 31, v1
    s_lshl_b32 s59, s58, 12
    v_lshl_add_u32 v6, v20, 7, s59
    v_bfe_u32 v25, v1, 1, 3
    v_xor_b32 v25, v24, v25
    v_lshl_add_u32 v6, v25, 4, v6
    v_xor_b32 v7, 32, v6
    v_xor_b32 v8, 64, v6
    v_xor_b32 v9, 96, v6
    s_lshl_b32 s60, s52, 2
    s_add_u32 s60, s60, s58
    s_lshl_b32 s68, s60, 16
    s_lshl_b32 s62, s53, 12
    s_add_u32 s68, s68, s62
    s_add_u32 s68, s68, 1048576
    s_lshl_b32 s69, s60, 10
    s_add_u32 s69, s69, 196608
    s_lshr_b32 s61, s58, 1
    s_lshl_b32 s66, s48, 1
    s_add_u32 s66, s66, s61
    s_lshl_b32 s66, s66, 16
    s_lshl_b32 s61, s61, 15
    s_add_u32 s66, s66, s61
    s_add_u32 s66, s66, 1048576
    s_lshl_b32 s67, s58, 13
    s_lshl_b32 s9, s48, 1
    s_lshr_b32 s59, s58, 1
    s_add_u32 s9, s9, s59
    s_lshl_b32 s9, s9, 10
    s_add_u32 s9, s9, 196608
    s_and_b32 s59, s49, 3
    s_mul_i32 s59, s59, 256
    s_add_u32 s9, s9, s59

    s_barrier
    ds_read_b64_tr_b16 v[48:49], v4 offset:0
    ds_read_b64_tr_b16 v[50:51], v4 offset:512
    ds_read_b128 v[16:19], v2 offset:0
    ds_read_b64_tr_b16 v[52:53], v4 offset:2048
    ds_read_b64_tr_b16 v[54:55], v4 offset:2560
    ds_read_b128 v[20:23], v2 offset:2048
    ds_read_b128 v[24:27], v2 offset:4096
    ds_read_b128 v[28:31], v2 offset:6144
    ds_read_b128 v[32:35], v2 offset:8192
    ds_read_b128 v[36:39], v2 offset:10240
    s_waitcnt lgkmcnt(4)
    v_mfma_f32_16x16x32_bf16 v[64:67], v[16:19], v[48:51], 1.0
    ds_read_b64_tr_b16 v[56:57], v4 offset:8192
    v_mfma_f32_16x16x32_bf16 v[96:99], v[16:19], v[52:55], 0
    ds_read_b128 v[40:43], v2 offset:12288
    v_mfma_f32_16x16x32_bf16 v[68:71], v[20:23], v[48:51], 1.0
    ds_read_b64_tr_b16 v[58:59], v4 offset:8704
    v_mfma_f32_16x16x32_bf16 v[100:103], v[20:23], v[52:55], 0
    ds_read_b128 v[44:47], v2 offset:14336
    s_waitcnt lgkmcnt(6)
    v_mfma_f32_16x16x32_bf16 v[72:75], v[24:27], v[48:51], 1.0
    ds_read_b64_tr_b16 v[60:61], v4 offset:10240
    v_mfma_f32_16x16x32_bf16 v[104:107], v[24:27], v[52:55], 0
    ds_read_b128 v[16:19], v3 offset:0
    v_mfma_f32_16x16x32_bf16 v[76:79], v[28:31], v[48:51], 1.0
    ds_read_b64_tr_b16 v[62:63], v4 offset:10752
    v_mfma_f32_16x16x32_bf16 v[108:111], v[28:31], v[52:55], 0
    ds_read_b128 v[20:23], v3 offset:2048
    s_waitcnt lgkmcnt(8)
    v_mfma_f32_16x16x32_bf16 v[80:83], v[32:35], v[48:51], 1.0
    ds_read_b128 v[128:131], v6 offset:0
    v_mfma_f32_16x16x32_bf16 v[112:115], v[32:35], v[52:55], 0
    ds_read_b128 v[24:27], v3 offset:4096
    v_mfma_f32_16x16x32_bf16 v[84:87], v[36:39], v[48:51], 1.0
    ds_read_b128 v[132:135], v7 offset:0
    v_mfma_f32_16x16x32_bf16 v[116:119], v[36:39], v[52:55], 0
    ds_read_b128 v[28:31], v3 offset:6144
    s_waitcnt lgkmcnt(8)
    v_mfma_f32_16x16x32_bf16 v[88:91], v[40:43], v[48:51], 1.0
    ds_read_b128 v[136:139], v8 offset:0
    v_mfma_f32_16x16x32_bf16 v[120:123], v[40:43], v[52:55], 0
    ds_read_b128 v[32:35], v3 offset:8192
    v_mfma_f32_16x16x32_bf16 v[92:95], v[44:47], v[48:51], 1.0
    ds_read_b128 v[140:143], v9 offset:0
    v_mfma_f32_16x16x32_bf16 v[124:127], v[44:47], v[52:55], 0
    ds_read_b128 v[36:39], v3 offset:10240
    s_waitcnt lgkmcnt(8)
    v_mfma_f32_16x16x32_bf16 v[64:67], v[16:19], v[56:59], v[64:67]
    v_mfma_f32_16x16x32_bf16 v[96:99], v[16:19], v[60:63], v[96:99]
    ds_read_b128 v[40:43], v3 offset:12288
    v_mfma_f32_16x16x32_bf16 v[68:71], v[20:23], v[56:59], v[68:71]
    v_mfma_f32_16x16x32_bf16 v[100:103], v[20:23], v[60:63], v[100:103]
    ds_read_b128 v[44:47], v3 offset:14336
    s_barrier
    s_waitcnt lgkmcnt(6)
    v_mfma_f32_16x16x32_bf16 v[72:75], v[24:27], v[56:59], v[72:75]
    ds_read_b64_tr_b16 v[48:49], v4 offset:32768
    ds_read_b64_tr_b16 v[50:51], v4 offset:33280
    v_mfma_f32_16x16x32_bf16 v[104:107], v[24:27], v[60:63], v[104:107]
    ds_read_b128 v[16:19], v2 offset:32768
    v_mfma_f32_16x16x32_bf16 v[76:79], v[28:31], v[56:59], v[76:79]
    ds_read_b64_tr_b16 v[52:53], v4 offset:34816
    ds_read_b64_tr_b16 v[54:55], v4 offset:35328
    v_mfma_f32_16x16x32_bf16 v[108:111], v[28:31], v[60:63], v[108:111]
    ds_read_b128 v[20:23], v2 offset:34816
    s_waitcnt lgkmcnt(8)
    v_mfma_f32_16x16x32_bf16 v[80:83], v[32:35], v[56:59], v[80:83]
    s_cmp_eq_u32 s52, s53
    s_cbranch_scc1 Lflag
Lflag_done:
    v_mfma_f32_16x16x32_bf16 v[112:115], v[32:35], v[60:63], v[112:115]
    ds_read_b128 v[24:27], v2 offset:36864
    v_mfma_f32_16x16x32_bf16 v[84:87], v[36:39], v[56:59], v[84:87]
    v_mfma_f32_16x16x32_bf16 v[116:119], v[36:39], v[60:63], v[116:119]
    ds_read_b128 v[28:31], v2 offset:38912
    s_waitcnt lgkmcnt(8)
    v_mfma_f32_16x16x32_bf16 v[88:91], v[40:43], v[56:59], v[88:91]
    v_mfma_f32_16x16x32_bf16 v[120:123], v[40:43], v[60:63], v[120:123]
    ds_read_b128 v[32:35], v2 offset:40960
    v_mfma_f32_16x16x32_bf16 v[92:95], v[44:47], v[56:59], v[92:95]
    v_mfma_f32_16x16x32_bf16 v[124:127], v[44:47], v[60:63], v[124:127]
    ds_read_b128 v[36:39], v2 offset:43008
    s_waitcnt lgkmcnt(4)
    v_mfma_f32_16x16x32_bf16 v[64:67], v[16:19], v[48:51], v[64:67]
    ds_read_b64_tr_b16 v[56:57], v4 offset:40960
    v_mfma_f32_16x16x32_bf16 v[96:99], v[16:19], v[52:55], v[96:99]
    ds_read_b128 v[40:43], v2 offset:45056
    v_mfma_f32_16x16x32_bf16 v[68:71], v[20:23], v[48:51], v[68:71]
    ds_read_b64_tr_b16 v[58:59], v4 offset:41472
    v_mfma_f32_16x16x32_bf16 v[100:103], v[20:23], v[52:55], v[100:103]
    ds_read_b128 v[44:47], v2 offset:47104
    s_waitcnt lgkmcnt(6)
    v_mfma_f32_16x16x32_bf16 v[72:75], v[24:27], v[48:51], v[72:75]
    ds_read_b64_tr_b16 v[60:61], v4 offset:43008
    v_mfma_f32_16x16x32_bf16 v[104:107], v[24:27], v[52:55], v[104:107]
    ds_read_b128 v[16:19], v3 offset:32768
    v_mfma_f32_16x16x32_bf16 v[76:79], v[28:31], v[48:51], v[76:79]
    ds_read_b64_tr_b16 v[62:63], v4 offset:43520
    v_mfma_f32_16x16x32_bf16 v[108:111], v[28:31], v[52:55], v[108:111]
    ds_read_b128 v[20:23], v3 offset:34816
    s_waitcnt lgkmcnt(8)
    v_mfma_f32_16x16x32_bf16 v[80:83], v[32:35], v[48:51], v[80:83]
    ds_read_b128 v[144:147], v6 offset:32768
    v_mfma_f32_16x16x32_bf16 v[112:115], v[32:35], v[52:55], v[112:115]
    ds_read_b128 v[24:27], v3 offset:36864
    v_mfma_f32_16x16x32_bf16 v[84:87], v[36:39], v[48:51], v[84:87]
    ds_read_b128 v[148:151], v7 offset:32768
    v_mfma_f32_16x16x32_bf16 v[116:119], v[36:39], v[52:55], v[116:119]
    ds_read_b128 v[28:31], v3 offset:38912
    s_waitcnt lgkmcnt(8)
    v_mfma_f32_16x16x32_bf16 v[88:91], v[40:43], v[48:51], v[88:91]
    ds_read_b128 v[152:155], v8 offset:32768
    v_mfma_f32_16x16x32_bf16 v[120:123], v[40:43], v[52:55], v[120:123]
    ds_read_b128 v[32:35], v3 offset:40960
    v_mfma_f32_16x16x32_bf16 v[92:95], v[44:47], v[48:51], v[92:95]
    ds_read_b128 v[156:159], v9 offset:32768
    v_mfma_f32_16x16x32_bf16 v[124:127], v[44:47], v[52:55], v[124:127]
    ds_read_b128 v[36:39], v3 offset:43008
    s_waitcnt lgkmcnt(8)
    v_mfma_f32_16x16x32_bf16 v[64:67], v[16:19], v[56:59], v[64:67]
    v_xor_b32 v2, 0x10000, v2
    v_xor_b32 v4, 0x10000, v4
    v_mfma_f32_16x16x32_bf16 v[96:99], v[16:19], v[60:63], v[96:99]
    ds_read_b128 v[40:43], v3 offset:45056
    v_mfma_f32_16x16x32_bf16 v[68:71], v[20:23], v[56:59], v[68:71]
    v_mfma_f32_16x16x32_bf16 v[100:103], v[20:23], v[60:63], v[100:103]
    ds_read_b128 v[44:47], v3 offset:47104
    s_barrier
    s_waitcnt lgkmcnt(6)
    v_mfma_f32_16x16x32_bf16 v[72:75], v[24:27], v[56:59], v[72:75]
    ds_read_b64_tr_b16 v[48:49], v4 offset:0
    ds_read_b64_tr_b16 v[50:51], v4 offset:512
    v_mfma_f32_16x16x32_bf16 v[104:107], v[24:27], v[60:63], v[104:107]
    ds_read_b128 v[16:19], v2 offset:0
    v_mfma_f32_16x16x32_bf16 v[76:79], v[28:31], v[56:59], v[76:79]
    ds_read_b64_tr_b16 v[52:53], v4 offset:2048
    ds_read_b64_tr_b16 v[54:55], v4 offset:2560
    v_mfma_f32_16x16x32_bf16 v[108:111], v[28:31], v[60:63], v[108:111]
    ds_read_b128 v[20:23], v2 offset:2048
    s_waitcnt lgkmcnt(8)
    v_mfma_f32_16x16x32_bf16 v[80:83], v[32:35], v[56:59], v[80:83]
    v_xor_b32 v6, 0x10000, v6
    v_xor_b32 v7, 0x10000, v7
    v_mfma_f32_16x16x32_bf16 v[112:115], v[32:35], v[60:63], v[112:115]
    ds_read_b128 v[24:27], v2 offset:4096
    v_mfma_f32_16x16x32_bf16 v[84:87], v[36:39], v[56:59], v[84:87]
    v_xor_b32 v8, 0x10000, v8
    v_xor_b32 v9, 0x10000, v9
    v_mfma_f32_16x16x32_bf16 v[116:119], v[36:39], v[60:63], v[116:119]
    ds_read_b128 v[28:31], v2 offset:6144
    s_waitcnt lgkmcnt(8)
    v_mfma_f32_16x16x32_bf16 v[88:91], v[40:43], v[56:59], v[88:91]
    v_xor_b32 v3, 0x10000, v3
    v_mfma_f32_16x16x32_bf16 v[120:123], v[40:43], v[60:63], v[120:123]
    ds_read_b128 v[32:35], v2 offset:8192
    v_mfma_f32_16x16x32_bf16 v[92:95], v[44:47], v[56:59], v[92:95]
    v_mfma_f32_16x16x32_bf16 v[124:127], v[44:47], v[60:63], v[124:127]
    ds_read_b128 v[36:39], v2 offset:10240
    s_waitcnt lgkmcnt(4)
    v_mfma_f32_16x16x32_bf16 v[64:67], v[16:19], v[48:51], v[64:67]
    ds_read_b64_tr_b16 v[56:57], v4 offset:8192
    v_mfma_f32_16x16x32_bf16 v[96:99], v[16:19], v[52:55], v[96:99]
    ds_read_b128 v[40:43], v2 offset:12288
    v_mfma_f32_16x16x32_bf16 v[68:71], v[20:23], v[48:51], v[68:71]
    ds_read_b64_tr_b16 v[58:59], v4 offset:8704
    v_mfma_f32_16x16x32_bf16 v[100:103], v[20:23], v[52:55], v[100:103]
    ds_read_b128 v[44:47], v2 offset:14336
    s_waitcnt lgkmcnt(6)
    v_mfma_f32_16x16x32_bf16 v[72:75], v[24:27], v[48:51], v[72:75]
    ds_read_b64_tr_b16 v[60:61], v4 offset:10240
    v_mfma_f32_16x16x32_bf16 v[104:107], v[24:27], v[52:55], v[104:107]
    ds_read_b128 v[16:19], v3 offset:0
    v_mfma_f32_16x16x32_bf16 v[76:79], v[28:31], v[48:51], v[76:79]
    ds_read_b64_tr_b16 v[62:63], v4 offset:10752
    v_mfma_f32_16x16x32_bf16 v[108:111], v[28:31], v[52:55], v[108:111]
    ds_read_b128 v[20:23], v3 offset:2048
    s_waitcnt lgkmcnt(8)
    v_mfma_f32_16x16x32_bf16 v[80:83], v[32:35], v[48:51], v[80:83]
    ds_read_b128 v[160:163], v6 offset:0
    v_mfma_f32_16x16x32_bf16 v[112:115], v[32:35], v[52:55], v[112:115]
    ds_read_b128 v[24:27], v3 offset:4096
    v_mfma_f32_16x16x32_bf16 v[84:87], v[36:39], v[48:51], v[84:87]
    ds_read_b128 v[164:167], v7 offset:0
    v_mfma_f32_16x16x32_bf16 v[116:119], v[36:39], v[52:55], v[116:119]
    ds_read_b128 v[28:31], v3 offset:6144
    s_waitcnt lgkmcnt(8)
    v_mfma_f32_16x16x32_bf16 v[88:91], v[40:43], v[48:51], v[88:91]
    ds_read_b128 v[168:171], v8 offset:0
    v_mfma_f32_16x16x32_bf16 v[120:123], v[40:43], v[52:55], v[120:123]
    ds_read_b128 v[32:35], v3 offset:8192
    v_mfma_f32_16x16x32_bf16 v[92:95], v[44:47], v[48:51], v[92:95]
    ds_read_b128 v[172:175], v9 offset:0
    v_mfma_f32_16x16x32_bf16 v[124:127], v[44:47], v[52:55], v[124:127]
    ds_read_b128 v[36:39], v3 offset:10240
    s_waitcnt lgkmcnt(8)
    v_mfma_f32_16x16x32_bf16 v[64:67], v[16:19], v[56:59], v[64:67]
    v_mfma_f32_16x16x32_bf16 v[96:99], v[16:19], v[60:63], v[96:99]
    ds_read_b128 v[40:43], v3 offset:12288
    v_mfma_f32_16x16x32_bf16 v[68:71], v[20:23], v[56:59], v[68:71]
    v_mfma_f32_16x16x32_bf16 v[100:103], v[20:23], v[60:63], v[100:103]
    ds_read_b128 v[44:47], v3 offset:14336
    s_barrier
    s_waitcnt lgkmcnt(6)
    v_mfma_f32_16x16x32_bf16 v[72:75], v[24:27], v[56:59], v[72:75]
    ds_read_b64_tr_b16 v[48:49], v4 offset:32768
    ds_read_b64_tr_b16 v[50:51], v4 offset:33280
    v_mfma_f32_16x16x32_bf16 v[104:107], v[24:27], v[60:63], v[104:107]
    ds_read_b128 v[16:19], v2 offset:32768
    v_mfma_f32_16x16x32_bf16 v[76:79], v[28:31], v[56:59], v[76:79]
    ds_read_b64_tr_b16 v[52:53], v4 offset:34816
    ds_read_b64_tr_b16 v[54:55], v4 offset:35328
    v_mfma_f32_16x16x32_bf16 v[108:111], v[28:31], v[60:63], v[108:111]
    ds_read_b128 v[20:23], v2 offset:34816
    s_waitcnt lgkmcnt(8)
    v_mfma_f32_16x16x32_bf16 v[80:83], v[32:35], v[56:59], v[80:83]
    v_mfma_f32_16x16x32_bf16 v[112:115], v[32:35], v[60:63], v[112:115]
    ds_read_b128 v[24:27], v2 offset:36864
    v_mfma_f32_16x16x32_bf16 v[84:87], v[36:39], v[56:59], v[84:87]
    v_mfma_f32_16x16x32_bf16 v[116:119], v[36:39], v[60:63], v[116:119]
    ds_read_b128 v[28:31], v2 offset:38912
    s_waitcnt lgkmcnt(8)
    v_mfma_f32_16x16x32_bf16 v[88:91], v[40:43], v[56:59], v[88:91]
    v_mfma_f32_16x16x32_bf16 v[120:123], v[40:43], v[60:63], v[120:123]
    ds_read_b128 v[32:35], v2 offset:40960
    v_mfma_f32_16x16x32_bf16 v[92:95], v[44:47], v[56:59], v[92:95]
    v_mfma_f32_16x16x32_bf16 v[124:127], v[44:47], v[60:63], v[124:127]
    ds_read_b128 v[36:39], v2 offset:43008
    s_waitcnt lgkmcnt(4)
    v_mfma_f32_16x16x32_bf16 v[64:67], v[16:19], v[48:51], v[64:67]
    ds_read_b64_tr_b16 v[56:57], v4 offset:40960
    v_mfma_f32_16x16x32_bf16 v[96:99], v[16:19], v[52:55], v[96:99]
    ds_read_b128 v[40:43], v2 offset:45056
    v_mfma_f32_16x16x32_bf16 v[68:71], v[20:23], v[48:51], v[68:71]
    ds_read_b64_tr_b16 v[58:59], v4 offset:41472
    v_mfma_f32_16x16x32_bf16 v[100:103], v[20:23], v[52:55], v[100:103]
    ds_read_b128 v[44:47], v2 offset:47104
    s_waitcnt lgkmcnt(6)
    v_mfma_f32_16x16x32_bf16 v[72:75], v[24:27], v[48:51], v[72:75]
    ds_read_b64_tr_b16 v[60:61], v4 offset:43008
    v_mfma_f32_16x16x32_bf16 v[104:107], v[24:27], v[52:55], v[104:107]
    ds_read_b128 v[16:19], v3 offset:32768
    v_mfma_f32_16x16x32_bf16 v[76:79], v[28:31], v[48:51], v[76:79]
    ds_read_b64_tr_b16 v[62:63], v4 offset:43520
    v_mfma_f32_16x16x32_bf16 v[108:111], v[28:31], v[52:55], v[108:111]
    ds_read_b128 v[20:23], v3 offset:34816
    s_waitcnt lgkmcnt(8)
    v_mfma_f32_16x16x32_bf16 v[80:83], v[32:35], v[48:51], v[80:83]
    ds_read_b128 v[176:179], v6 offset:32768
    v_mfma_f32_16x16x32_bf16 v[112:115], v[32:35], v[52:55], v[112:115]
    ds_read_b128 v[24:27], v3 offset:36864
    v_mfma_f32_16x16x32_bf16 v[84:87], v[36:39], v[48:51], v[84:87]
    ds_read_b128 v[180:183], v7 offset:32768
    v_mfma_f32_16x16x32_bf16 v[116:119], v[36:39], v[52:55], v[116:119]
    ds_read_b128 v[28:31], v3 offset:38912
    s_waitcnt lgkmcnt(8)
    v_mfma_f32_16x16x32_bf16 v[88:91], v[40:43], v[48:51], v[88:91]
    ds_read_b128 v[184:187], v8 offset:32768
    v_mfma_f32_16x16x32_bf16 v[120:123], v[40:43], v[52:55], v[120:123]
    ds_read_b128 v[32:35], v3 offset:40960
    v_mfma_f32_16x16x32_bf16 v[92:95], v[44:47], v[48:51], v[92:95]
    ds_read_b128 v[188:191], v9 offset:32768
    v_mfma_f32_16x16x32_bf16 v[124:127], v[44:47], v[52:55], v[124:127]
    ds_read_b128 v[36:39], v3 offset:43008
    s_waitcnt lgkmcnt(8)
    v_mfma_f32_16x16x32_bf16 v[64:67], v[16:19], v[56:59], v[64:67]
    v_xor_b32 v2, 0x10000, v2
    v_xor_b32 v4, 0x10000, v4
    v_mfma_f32_16x16x32_bf16 v[96:99], v[16:19], v[60:63], v[96:99]
    ds_read_b128 v[40:43], v3 offset:45056
    v_mfma_f32_16x16x32_bf16 v[68:71], v[20:23], v[56:59], v[68:71]
    v_mfma_f32_16x16x32_bf16 v[100:103], v[20:23], v[60:63], v[100:103]
    ds_read_b128 v[44:47], v3 offset:47104
    s_barrier
    s_waitcnt lgkmcnt(6)
    v_mfma_f32_16x16x32_bf16 v[72:75], v[24:27], v[56:59], v[72:75]
    ds_read_b64_tr_b16 v[48:49], v4 offset:0
    ds_read_b64_tr_b16 v[50:51], v4 offset:512
    v_mfma_f32_16x16x32_bf16 v[104:107], v[24:27], v[60:63], v[104:107]
    ds_read_b128 v[16:19], v2 offset:0
    v_mfma_f32_16x16x32_bf16 v[76:79], v[28:31], v[56:59], v[76:79]
    ds_read_b64_tr_b16 v[52:53], v4 offset:2048
    ds_read_b64_tr_b16 v[54:55], v4 offset:2560
    v_mfma_f32_16x16x32_bf16 v[108:111], v[28:31], v[60:63], v[108:111]
    ds_read_b128 v[20:23], v2 offset:2048
    s_waitcnt lgkmcnt(8)
    v_mfma_f32_16x16x32_bf16 v[80:83], v[32:35], v[56:59], v[80:83]
    v_xor_b32 v6, 0x10000, v6
    v_xor_b32 v7, 0x10000, v7
    v_mfma_f32_16x16x32_bf16 v[112:115], v[32:35], v[60:63], v[112:115]
    ds_read_b128 v[24:27], v2 offset:4096
    v_mfma_f32_16x16x32_bf16 v[84:87], v[36:39], v[56:59], v[84:87]
    v_xor_b32 v8, 0x10000, v8
    v_xor_b32 v9, 0x10000, v9
    v_mfma_f32_16x16x32_bf16 v[116:119], v[36:39], v[60:63], v[116:119]
    ds_read_b128 v[28:31], v2 offset:6144
    s_waitcnt lgkmcnt(8)
    v_mfma_f32_16x16x32_bf16 v[88:91], v[40:43], v[56:59], v[88:91]
    v_xor_b32 v3, 0x10000, v3
    v_mfma_f32_16x16x32_bf16 v[120:123], v[40:43], v[60:63], v[120:123]
    ds_read_b128 v[32:35], v2 offset:8192
    v_mfma_f32_16x16x32_bf16 v[92:95], v[44:47], v[56:59], v[92:95]
    v_mfma_f32_16x16x32_bf16 v[124:127], v[44:47], v[60:63], v[124:127]
    ds_read_b128 v[36:39], v2 offset:10240
    s_waitcnt lgkmcnt(4)
    v_mfma_f32_16x16x32_bf16 v[64:67], v[16:19], v[48:51], v[64:67]
    ds_read_b64_tr_b16 v[56:57], v4 offset:8192
    v_mfma_f32_16x16x32_bf16 v[96:99], v[16:19], v[52:55], v[96:99]
    ds_read_b128 v[40:43], v2 offset:12288
    v_mfma_f32_16x16x32_bf16 v[68:71], v[20:23], v[48:51], v[68:71]
    ds_read_b64_tr_b16 v[58:59], v4 offset:8704
    v_mfma_f32_16x16x32_bf16 v[100:103], v[20:23], v[52:55], v[100:103]
    ds_read_b128 v[44:47], v2 offset:14336
    s_waitcnt lgkmcnt(6)
    v_mfma_f32_16x16x32_bf16 v[72:75], v[24:27], v[48:51], v[72:75]
    ds_read_b64_tr_b16 v[60:61], v4 offset:10240
    v_mfma_f32_16x16x32_bf16 v[104:107], v[24:27], v[52:55], v[104:107]
    ds_read_b128 v[16:19], v3 offset:0
    v_mfma_f32_16x16x32_bf16 v[76:79], v[28:31], v[48:51], v[76:79]
    ds_read_b64_tr_b16 v[62:63], v4 offset:10752
    v_mfma_f32_16x16x32_bf16 v[108:111], v[28:31], v[52:55], v[108:111]
    ds_read_b128 v[20:23], v3 offset:2048
    s_waitcnt lgkmcnt(8)
    v_mfma_f32_16x16x32_bf16 v[80:83], v[32:35], v[48:51], v[80:83]
    ds_read_b128 v[192:195], v6 offset:0
    v_mfma_f32_16x16x32_bf16 v[112:115], v[32:35], v[52:55], v[112:115]
    ds_read_b128 v[24:27], v3 offset:4096
    v_mfma_f32_16x16x32_bf16 v[84:87], v[36:39], v[48:51], v[84:87]
    ds_read_b128 v[196:199], v7 offset:0
    v_mfma_f32_16x16x32_bf16 v[116:119], v[36:39], v[52:55], v[116:119]
    ds_read_b128 v[28:31], v3 offset:6144
    s_waitcnt lgkmcnt(8)
    v_mfma_f32_16x16x32_bf16 v[88:91], v[40:43], v[48:51], v[88:91]
    ds_read_b128 v[200:203], v8 offset:0
    v_mfma_f32_16x16x32_bf16 v[120:123], v[40:43], v[52:55], v[120:123]
    ds_read_b128 v[32:35], v3 offset:8192
    v_mfma_f32_16x16x32_bf16 v[92:95], v[44:47], v[48:51], v[92:95]
    ds_read_b128 v[204:207], v9 offset:0
    v_mfma_f32_16x16x32_bf16 v[124:127], v[44:47], v[52:55], v[124:127]
    ds_read_b128 v[36:39], v3 offset:10240
    s_waitcnt lgkmcnt(8)
    v_mfma_f32_16x16x32_bf16 v[64:67], v[16:19], v[56:59], v[64:67]
    v_mfma_f32_16x16x32_bf16 v[96:99], v[16:19], v[60:63], v[96:99]
    ds_read_b128 v[40:43], v3 offset:12288
    v_mfma_f32_16x16x32_bf16 v[68:71], v[20:23], v[56:59], v[68:71]
    v_mfma_f32_16x16x32_bf16 v[100:103], v[20:23], v[60:63], v[100:103]
    ds_read_b128 v[44:47], v3 offset:14336
    s_barrier
    s_waitcnt lgkmcnt(6)
    v_mfma_f32_16x16x32_bf16 v[72:75], v[24:27], v[56:59], v[72:75]
    ds_read_b64_tr_b16 v[48:49], v4 offset:32768
    ds_read_b64_tr_b16 v[50:51], v4 offset:33280
    v_mfma_f32_16x16x32_bf16 v[104:107], v[24:27], v[60:63], v[104:107]
    ds_read_b128 v[16:19], v2 offset:32768
    v_mfma_f32_16x16x32_bf16 v[76:79], v[28:31], v[56:59], v[76:79]
    ds_read_b64_tr_b16 v[52:53], v4 offset:34816
    ds_read_b64_tr_b16 v[54:55], v4 offset:35328
    v_mfma_f32_16x16x32_bf16 v[108:111], v[28:31], v[60:63], v[108:111]
    ds_read_b128 v[20:23], v2 offset:34816
    s_waitcnt lgkmcnt(8)
    v_mfma_f32_16x16x32_bf16 v[80:83], v[32:35], v[56:59], v[80:83]
    s_waitcnt vmcnt(0)
    v_mfma_f32_16x16x32_bf16 v[112:115], v[32:35], v[60:63], v[112:115]
    ds_read_b128 v[24:27], v2 offset:36864
    v_mfma_f32_16x16x32_bf16 v[84:87], v[36:39], v[56:59], v[84:87]
    v_mfma_f32_16x16x32_bf16 v[116:119], v[36:39], v[60:63], v[116:119]
    ds_read_b128 v[28:31], v2 offset:38912
    s_waitcnt lgkmcnt(8)
    v_mfma_f32_16x16x32_bf16 v[88:91], v[40:43], v[56:59], v[88:91]
    v_mfma_f32_16x16x32_bf16 v[120:123], v[40:43], v[60:63], v[120:123]
    ds_read_b128 v[32:35], v2 offset:40960
    v_mfma_f32_16x16x32_bf16 v[92:95], v[44:47], v[56:59], v[92:95]
    v_mfma_f32_16x16x32_bf16 v[124:127], v[44:47], v[60:63], v[124:127]
    ds_read_b128 v[36:39], v2 offset:43008
    s_waitcnt lgkmcnt(4)
    v_mfma_f32_16x16x32_bf16 v[64:67], v[16:19], v[48:51], v[64:67]
    ds_read_b64_tr_b16 v[56:57], v4 offset:40960
    v_mfma_f32_16x16x32_bf16 v[96:99], v[16:19], v[52:55], v[96:99]
    ds_read_b128 v[40:43], v2 offset:45056
    v_mfma_f32_16x16x32_bf16 v[68:71], v[20:23], v[48:51], v[68:71]
    ds_read_b64_tr_b16 v[58:59], v4 offset:41472
    v_mfma_f32_16x16x32_bf16 v[100:103], v[20:23], v[52:55], v[100:103]
    ds_read_b128 v[44:47], v2 offset:47104
    s_waitcnt lgkmcnt(6)
    v_mfma_f32_16x16x32_bf16 v[72:75], v[24:27], v[48:51], v[72:75]
    ds_read_b64_tr_b16 v[60:61], v4 offset:43008
    v_mfma_f32_16x16x32_bf16 v[104:107], v[24:27], v[52:55], v[104:107]
    ds_read_b128 v[16:19], v3 offset:32768
    v_mfma_f32_16x16x32_bf16 v[76:79], v[28:31], v[48:51], v[76:79]
    ds_read_b64_tr_b16 v[62:63], v4 offset:43520
    v_mfma_f32_16x16x32_bf16 v[108:111], v[28:31], v[52:55], v[108:111]
    ds_read_b128 v[20:23], v3 offset:34816
    s_waitcnt lgkmcnt(8)
    v_mfma_f32_16x16x32_bf16 v[80:83], v[32:35], v[48:51], v[80:83]
    ds_read_b128 v[208:211], v6 offset:32768
    v_mfma_f32_16x16x32_bf16 v[112:115], v[32:35], v[52:55], v[112:115]
    ds_read_b128 v[24:27], v3 offset:36864
    v_mfma_f32_16x16x32_bf16 v[84:87], v[36:39], v[48:51], v[84:87]
    ds_read_b128 v[212:215], v7 offset:32768
    v_mfma_f32_16x16x32_bf16 v[116:119], v[36:39], v[52:55], v[116:119]
    ds_read_b128 v[28:31], v3 offset:38912
    s_waitcnt lgkmcnt(8)
    v_mfma_f32_16x16x32_bf16 v[88:91], v[40:43], v[48:51], v[88:91]
    ds_read_b128 v[216:219], v8 offset:32768
    v_mfma_f32_16x16x32_bf16 v[120:123], v[40:43], v[52:55], v[120:123]
    ds_read_b128 v[32:35], v3 offset:40960
    v_mfma_f32_16x16x32_bf16 v[92:95], v[44:47], v[48:51], v[92:95]
    ds_read_b128 v[220:223], v9 offset:32768
    v_mfma_f32_16x16x32_bf16 v[124:127], v[44:47], v[52:55], v[124:127]
    ds_read_b128 v[36:39], v3 offset:43008
    s_waitcnt lgkmcnt(8)
    v_mfma_f32_16x16x32_bf16 v[64:67], v[16:19], v[56:59], v[64:67]
    v_xor_b32 v2, 0x10000, v2
    v_xor_b32 v4, 0x10000, v4
    v_mfma_f32_16x16x32_bf16 v[96:99], v[16:19], v[60:63], v[96:99]
    ds_read_b128 v[40:43], v3 offset:45056
    v_mfma_f32_16x16x32_bf16 v[68:71], v[20:23], v[56:59], v[68:71]
    v_mfma_f32_16x16x32_bf16 v[100:103], v[20:23], v[60:63], v[100:103]
    ds_read_b128 v[44:47], v3 offset:47104
    s_barrier
    s_waitcnt lgkmcnt(6)
    v_mfma_f32_16x16x32_bf16 v[72:75], v[24:27], v[56:59], v[72:75]
    ds_read_b64_tr_b16 v[48:49], v4 offset:0
    ds_read_b64_tr_b16 v[50:51], v4 offset:512
    v_mfma_f32_16x16x32_bf16 v[104:107], v[24:27], v[60:63], v[104:107]
    ds_read_b128 v[16:19], v2 offset:0
    v_mfma_f32_16x16x32_bf16 v[76:79], v[28:31], v[56:59], v[76:79]
    ds_read_b64_tr_b16 v[52:53], v4 offset:2048
    ds_read_b64_tr_b16 v[54:55], v4 offset:2560
    v_mfma_f32_16x16x32_bf16 v[108:111], v[28:31], v[60:63], v[108:111]
    ds_read_b128 v[20:23], v2 offset:2048
    s_waitcnt lgkmcnt(8)
    v_mfma_f32_16x16x32_bf16 v[80:83], v[32:35], v[56:59], v[80:83]
    v_xor_b32 v6, 0x10000, v6
    v_xor_b32 v7, 0x10000, v7
    v_mfma_f32_16x16x32_bf16 v[112:115], v[32:35], v[60:63], v[112:115]
    ds_read_b128 v[24:27], v2 offset:4096
    v_mfma_f32_16x16x32_bf16 v[84:87], v[36:39], v[56:59], v[84:87]
    v_xor_b32 v8, 0x10000, v8
    v_xor_b32 v9, 0x10000, v9
    v_mfma_f32_16x16x32_bf16 v[116:119], v[36:39], v[60:63], v[116:119]
    ds_read_b128 v[28:31], v2 offset:6144
    s_waitcnt lgkmcnt(8)
    v_mfma_f32_16x16x32_bf16 v[88:91], v[40:43], v[56:59], v[88:91]
    v_xor_b32 v3, 0x10000, v3
    v_mfma_f32_16x16x32_bf16 v[120:123], v[40:43], v[60:63], v[120:123]
    ds_read_b128 v[32:35], v2 offset:8192
    v_mfma_f32_16x16x32_bf16 v[92:95], v[44:47], v[56:59], v[92:95]
    v_mfma_f32_16x16x32_bf16 v[124:127], v[44:47], v[60:63], v[124:127]
    ds_read_b128 v[36:39], v2 offset:10240
    s_waitcnt lgkmcnt(4)
    v_mfma_f32_16x16x32_bf16 v[64:67], v[16:19], v[48:51], v[64:67]
    ds_read_b64_tr_b16 v[56:57], v4 offset:8192
    v_mfma_f32_16x16x32_bf16 v[96:99], v[16:19], v[52:55], v[96:99]
    ds_read_b128 v[40:43], v2 offset:12288
    v_mfma_f32_16x16x32_bf16 v[68:71], v[20:23], v[48:51], v[68:71]
    ds_read_b64_tr_b16 v[58:59], v4 offset:8704
    v_mfma_f32_16x16x32_bf16 v[100:103], v[20:23], v[52:55], v[100:103]
    ds_read_b128 v[44:47], v2 offset:14336
    s_waitcnt lgkmcnt(6)
    v_mfma_f32_16x16x32_bf16 v[72:75], v[24:27], v[48:51], v[72:75]
    ds_read_b64_tr_b16 v[60:61], v4 offset:10240
    v_mfma_f32_16x16x32_bf16 v[104:107], v[24:27], v[52:55], v[104:107]
    ds_read_b128 v[16:19], v3 offset:0
    v_mfma_f32_16x16x32_bf16 v[76:79], v[28:31], v[48:51], v[76:79]
    ds_read_b64_tr_b16 v[62:63], v4 offset:10752
    v_mfma_f32_16x16x32_bf16 v[108:111], v[28:31], v[52:55], v[108:111]
    ds_read_b128 v[20:23], v3 offset:2048
    s_waitcnt lgkmcnt(8)
    v_mfma_f32_16x16x32_bf16 v[80:83], v[32:35], v[48:51], v[80:83]
    ds_read_b128 v[224:227], v6 offset:0
    v_mfma_f32_16x16x32_bf16 v[112:115], v[32:35], v[52:55], v[112:115]
    ds_read_b128 v[24:27], v3 offset:4096
    v_mfma_f32_16x16x32_bf16 v[84:87], v[36:39], v[48:51], v[84:87]
    ds_read_b128 v[228:231], v7 offset:0
    v_mfma_f32_16x16x32_bf16 v[116:119], v[36:39], v[52:55], v[116:119]
    ds_read_b128 v[28:31], v3 offset:6144
    s_waitcnt lgkmcnt(8)
    v_mfma_f32_16x16x32_bf16 v[88:91], v[40:43], v[48:51], v[88:91]
    ds_read_b128 v[232:235], v8 offset:0
    v_mfma_f32_16x16x32_bf16 v[120:123], v[40:43], v[52:55], v[120:123]
    ds_read_b128 v[32:35], v3 offset:8192
    v_mfma_f32_16x16x32_bf16 v[92:95], v[44:47], v[48:51], v[92:95]
    ds_read_b128 v[236:239], v9 offset:0
    v_mfma_f32_16x16x32_bf16 v[124:127], v[44:47], v[52:55], v[124:127]
    ds_read_b128 v[36:39], v3 offset:10240
    s_waitcnt lgkmcnt(8)
    v_mfma_f32_16x16x32_bf16 v[64:67], v[16:19], v[56:59], v[64:67]
    v_mfma_f32_16x16x32_bf16 v[96:99], v[16:19], v[60:63], v[96:99]
    ds_read_b128 v[40:43], v3 offset:12288
    v_mfma_f32_16x16x32_bf16 v[68:71], v[20:23], v[56:59], v[68:71]
    v_mfma_f32_16x16x32_bf16 v[100:103], v[20:23], v[60:63], v[100:103]
    ds_read_b128 v[44:47], v3 offset:14336
    s_barrier
    s_waitcnt lgkmcnt(6)
    v_mfma_f32_16x16x32_bf16 v[72:75], v[24:27], v[56:59], v[72:75]
    ds_read_b64_tr_b16 v[48:49], v4 offset:32768
    ds_read_b64_tr_b16 v[50:51], v4 offset:33280
    v_mfma_f32_16x16x32_bf16 v[104:107], v[24:27], v[60:63], v[104:107]
    ds_read_b128 v[16:19], v2 offset:32768
    v_mfma_f32_16x16x32_bf16 v[76:79], v[28:31], v[56:59], v[76:79]
    ds_read_b64_tr_b16 v[52:53], v4 offset:34816
    ds_read_b64_tr_b16 v[54:55], v4 offset:35328
    v_mfma_f32_16x16x32_bf16 v[108:111], v[28:31], v[60:63], v[108:111]
    ds_read_b128 v[20:23], v2 offset:34816
    s_waitcnt lgkmcnt(8)
    v_mfma_f32_16x16x32_bf16 v[80:83], v[32:35], v[56:59], v[80:83]
    v_mfma_f32_16x16x32_bf16 v[112:115], v[32:35], v[60:63], v[112:115]
    ds_read_b128 v[24:27], v2 offset:36864
    v_mfma_f32_16x16x32_bf16 v[84:87], v[36:39], v[56:59], v[84:87]
    v_mfma_f32_16x16x32_bf16 v[116:119], v[36:39], v[60:63], v[116:119]
    ds_read_b128 v[28:31], v2 offset:38912
    s_waitcnt lgkmcnt(8)
    v_mfma_f32_16x16x32_bf16 v[88:91], v[40:43], v[56:59], v[88:91]
    v_mfma_f32_16x16x32_bf16 v[120:123], v[40:43], v[60:63], v[120:123]
    ds_read_b128 v[32:35], v2 offset:40960
    v_mfma_f32_16x16x32_bf16 v[92:95], v[44:47], v[56:59], v[92:95]
    v_mfma_f32_16x16x32_bf16 v[124:127], v[44:47], v[60:63], v[124:127]
    ds_read_b128 v[36:39], v2 offset:43008
    s_waitcnt lgkmcnt(4)
    v_mfma_f32_16x16x32_bf16 v[64:67], v[16:19], v[48:51], v[64:67]
    ds_read_b64_tr_b16 v[56:57], v4 offset:40960
    v_mfma_f32_16x16x32_bf16 v[96:99], v[16:19], v[52:55], v[96:99]
    ds_read_b128 v[40:43], v2 offset:45056
    v_mfma_f32_16x16x32_bf16 v[68:71], v[20:23], v[48:51], v[68:71]
    ds_read_b64_tr_b16 v[58:59], v4 offset:41472
    v_mfma_f32_16x16x32_bf16 v[100:103], v[20:23], v[52:55], v[100:103]
    ds_read_b128 v[44:47], v2 offset:47104
    s_waitcnt lgkmcnt(6)
    v_mfma_f32_16x16x32_bf16 v[72:75], v[24:27], v[48:51], v[72:75]
    ds_read_b64_tr_b16 v[60:61], v4 offset:43008
    v_mfma_f32_16x16x32_bf16 v[104:107], v[24:27], v[52:55], v[104:107]
    ds_read_b128 v[16:19], v3 offset:32768
    v_mfma_f32_16x16x32_bf16 v[76:79], v[28:31], v[48:51], v[76:79]
    ds_read_b64_tr_b16 v[62:63], v4 offset:43520
    v_mfma_f32_16x16x32_bf16 v[108:111], v[28:31], v[52:55], v[108:111]
    ds_read_b128 v[20:23], v3 offset:34816
    s_waitcnt lgkmcnt(8)
    v_mfma_f32_16x16x32_bf16 v[80:83], v[32:35], v[48:51], v[80:83]
    ds_read_b128 v[240:243], v6 offset:32768
    v_mfma_f32_16x16x32_bf16 v[112:115], v[32:35], v[52:55], v[112:115]
    ds_read_b128 v[24:27], v3 offset:36864
    v_mfma_f32_16x16x32_bf16 v[84:87], v[36:39], v[48:51], v[84:87]
    ds_read_b128 v[244:247], v7 offset:32768
    v_mfma_f32_16x16x32_bf16 v[116:119], v[36:39], v[52:55], v[116:119]
    ds_read_b128 v[28:31], v3 offset:38912
    s_waitcnt lgkmcnt(8)
    v_mfma_f32_16x16x32_bf16 v[88:91], v[40:43], v[48:51], v[88:91]
    ds_read_b128 v[248:251], v8 offset:32768
    v_mfma_f32_16x16x32_bf16 v[120:123], v[40:43], v[52:55], v[120:123]
    ds_read_b128 v[32:35], v3 offset:40960
    v_mfma_f32_16x16x32_bf16 v[92:95], v[44:47], v[48:51], v[92:95]
    ds_read_b128 v[252:255], v9 offset:32768
    v_mfma_f32_16x16x32_bf16 v[124:127], v[44:47], v[52:55], v[124:127]
    ds_read_b128 v[36:39], v3 offset:43008
    s_waitcnt lgkmcnt(8)
    v_mfma_f32_16x16x32_bf16 v[64:67], v[16:19], v[56:59], v[64:67]
    v_mfma_f32_16x16x32_bf16 v[96:99], v[16:19], v[60:63], v[96:99]
    ds_read_b128 v[40:43], v3 offset:45056
    v_mfma_f32_16x16x32_bf16 v[68:71], v[20:23], v[56:59], v[68:71]
    v_mfma_f32_16x16x32_bf16 v[100:103], v[20:23], v[60:63], v[100:103]
    ds_read_b128 v[44:47], v3 offset:47104
    s_waitcnt lgkmcnt(8)
    v_mfma_f32_16x16x32_bf16 v[72:75], v[24:27], v[56:59], v[72:75]
    s_waitcnt lgkmcnt(6)
    v_mfma_f32_16x16x32_bf16 v[76:79], v[28:31], v[56:59], v[76:79]
    s_waitcnt lgkmcnt(4)
    v_mfma_f32_16x16x32_bf16 v[80:83], v[32:35], v[56:59], v[80:83]
    s_waitcnt lgkmcnt(2)
    v_mfma_f32_16x16x32_bf16 v[84:87], v[36:39], v[56:59], v[84:87]
    s_waitcnt lgkmcnt(1)
    v_mfma_f32_16x16x32_bf16 v[88:91], v[40:43], v[56:59], v[88:91]
    s_waitcnt lgkmcnt(0)
    v_mfma_f32_16x16x32_bf16 v[92:95], v[44:47], v[56:59], v[92:95]
    s_mov_b64 exec, 1
    ds_add_u32 v12, v13 offset:12
    s_mov_b64 exec, -1
    v_mfma_f32_16x16x32_bf16 v[104:107], v[24:27], v[60:63], v[104:107]
    v_mfma_f32_16x16x32_bf16 v[108:111], v[28:31], v[60:63], v[108:111]
    v_mfma_f32_16x16x32_bf16 v[112:115], v[32:35], v[60:63], v[112:115]
    v_mfma_f32_16x16x32_bf16 v[116:119], v[36:39], v[60:63], v[116:119]
    v_mfma_f32_16x16x32_bf16 v[120:123], v[40:43], v[60:63], v[120:123]
    v_mfma_f32_16x16x32_bf16 v[124:127], v[44:47], v[60:63], v[124:127]
    v_pk_fma_f32 v[16:17], v[64:65], s[36:37], s[36:37] neg_lo:[0,0,1] neg_hi:[0,0,1]
    v_pk_fma_f32 v[18:19], v[66:67], s[36:37], s[36:37] neg_lo:[0,0,1] neg_hi:[0,0,1]
    v_pk_fma_f32 v[20:21], v[68:69], s[36:37], s[36:37] neg_lo:[0,0,1] neg_hi:[0,0,1]
    v_pk_fma_f32 v[22:23], v[70:71], s[36:37], s[36:37] neg_lo:[0,0,1] neg_hi:[0,0,1]
    v_pk_fma_f32 v[24:25], v[72:73], s[36:37], s[36:37] neg_lo:[0,0,1] neg_hi:[0,0,1]
    v_pk_fma_f32 v[26:27], v[74:75], s[36:37], s[36:37] neg_lo:[0,0,1] neg_hi:[0,0,1]
    v_pk_fma_f32 v[28:29], v[76:77], s[36:37], s[36:37] neg_lo:[0,0,1] neg_hi:[0,0,1]
    v_pk_fma_f32 v[30:31], v[78:79], s[36:37], s[36:37] neg_lo:[0,0,1] neg_hi:[0,0,1]
    v_pk_fma_f32 v[32:33], v[80:81], s[36:37], s[36:37] neg_lo:[0,0,1] neg_hi:[0,0,1]
    v_pk_fma_f32 v[34:35], v[82:83], s[36:37], s[36:37] neg_lo:[0,0,1] neg_hi:[0,0,1]
    v_pk_fma_f32 v[36:37], v[84:85], s[36:37], s[36:37] neg_lo:[0,0,1] neg_hi:[0,0,1]
    v_pk_fma_f32 v[38:39], v[86:87], s[36:37], s[36:37] neg_lo:[0,0,1] neg_hi:[0,0,1]
    v_pk_fma_f32 v[40:41], v[88:89], s[36:37], s[36:37] neg_lo:[0,0,1] neg_hi:[0,0,1]
    v_pk_fma_f32 v[42:43], v[90:91], s[36:37], s[36:37] neg_lo:[0,0,1] neg_hi:[0,0,1]
    v_pk_fma_f32 v[44:45], v[92:93], s[36:37], s[36:37] neg_lo:[0,0,1] neg_hi:[0,0,1]
    v_pk_fma_f32 v[46:47], v[94:95], s[36:37], s[36:37] neg_lo:[0,0,1] neg_hi:[0,0,1]
    v_exp_f32 v16, v16 clamp
    v_exp_f32 v17, v17 clamp
    v_exp_f32 v18, v18 clamp
    v_max_f32 v64, v64, v16
    v_exp_f32 v19, v19 clamp
    v_max_f32 v65, v65, v17
    v_exp_f32 v20, v20 clamp
    v_max_f32 v66, v66, v18
    v_exp_f32 v21, v21 clamp
    v_max_f32 v67, v67, v19
    v_exp_f32 v22, v22 clamp
    v_max_f32 v68, v68, v20
    v_exp_f32 v23, v23 clamp
    v_max_f32 v69, v69, v21
    v_exp_f32 v24, v24 clamp
    v_max_f32 v70, v70, v22
    v_exp_f32 v25, v25 clamp
    v_max_f32 v71, v71, v23
    v_exp_f32 v26, v26 clamp
    v_max_f32 v72, v72, v24
    v_exp_f32 v27, v27 clamp
    v_max_f32 v73, v73, v25
    v_exp_f32 v28, v28 clamp
    v_max_f32 v74, v74, v26
    v_exp_f32 v29, v29 clamp
    v_max_f32 v75, v75, v27
    v_exp_f32 v30, v30 clamp
    v_max_f32 v76, v76, v28
    v_exp_f32 v31, v31 clamp
    v_max_f32 v77, v77, v29
    v_exp_f32 v32, v32 clamp
    v_max_f32 v78, v78, v30
    v_exp_f32 v33, v33 clamp
    v_max_f32 v79, v79, v31
    v_exp_f32 v34, v34 clamp
    v_max_f32 v80, v80, v32
    v_exp_f32 v35, v35 clamp
    v_max_f32 v81, v81, v33
    v_exp_f32 v36, v36 clamp
    v_max_f32 v82, v82, v34
    v_exp_f32 v37, v37 clamp
    v_max_f32 v83, v83, v35
    v_exp_f32 v38, v38 clamp
    v_max_f32 v84, v84, v36
    v_exp_f32 v39, v39 clamp
    v_max_f32 v85, v85, v37
    v_exp_f32 v40, v40 clamp
    v_max_f32 v86, v86, v38
    v_exp_f32 v41, v41 clamp
    v_max_f32 v87, v87, v39
    v_exp_f32 v42, v42 clamp
    v_max_f32 v88, v88, v40
    v_exp_f32 v43, v43 clamp
    v_max_f32 v89, v89, v41
    v_exp_f32 v44, v44 clamp
    v_max_f32 v90, v90, v42
    v_exp_f32 v45, v45 clamp
    v_max_f32 v91, v91, v43
    v_exp_f32 v46, v46 clamp
    v_max_f32 v92, v92, v44
    v_exp_f32 v47, v47 clamp
    v_max_f32 v93, v93, v45
    v_max_f32 v94, v94, v46
    v_max_f32 v95, v95, v47
    v_pk_add_f32 v[64:65], v[64:65], s[38:39]
    v_pk_add_f32 v[66:67], v[66:67], s[38:39]
    v_pk_add_f32 v[68:69], v[68:69], s[38:39]
    v_pk_add_f32 v[70:71], v[70:71], s[38:39]
    v_pk_add_f32 v[72:73], v[72:73], s[38:39]
    v_pk_add_f32 v[74:75], v[74:75], s[38:39]
    v_pk_add_f32 v[76:77], v[76:77], s[38:39]
    v_pk_add_f32 v[78:79], v[78:79], s[38:39]
    v_pk_add_f32 v[80:81], v[80:81], s[38:39]
    v_pk_add_f32 v[82:83], v[82:83], s[38:39]
    v_pk_add_f32 v[84:85], v[84:85], s[38:39]
    v_pk_add_f32 v[86:87], v[86:87], s[38:39]
    v_pk_add_f32 v[88:89], v[88:89], s[38:39]
    v_pk_add_f32 v[90:91], v[90:91], s[38:39]
    v_pk_add_f32 v[92:93], v[92:93], s[38:39]
    v_pk_add_f32 v[94:95], v[94:95], s[38:39]
    v_cvt_pk_bf16_f32 v64, v64, v65
    v_cvt_pk_bf16_f32 v65, v66, v67
    v_cvt_pk_bf16_f32 v66, v68, v69
    v_cvt_pk_bf16_f32 v67, v70, v71
    v_cvt_pk_bf16_f32 v68, v72, v73
    v_cvt_pk_bf16_f32 v69, v74, v75
    v_cvt_pk_bf16_f32 v70, v76, v77
    v_cvt_pk_bf16_f32 v71, v78, v79
    v_cvt_pk_bf16_f32 v72, v80, v81
    v_cvt_pk_bf16_f32 v73, v82, v83
    v_cvt_pk_bf16_f32 v74, v84, v85
    v_cvt_pk_bf16_f32 v75, v86, v87
    v_cvt_pk_bf16_f32 v76, v88, v89
    v_cvt_pk_bf16_f32 v77, v90, v91
    v_cvt_pk_bf16_f32 v78, v92, v93
    v_cvt_pk_bf16_f32 v79, v94, v95
    ds_read_b32 v2, v12
    v_mov_b32 v60, 0x3f803f80
    v_mov_b32 v61, 0x3f803f80
    v_mov_b32 v62, 0x3f803f80
    v_mov_b32 v63, 0x3f803f80
    v_cvt_pk_bf16_f32 v96, v96, v97
    v_cvt_pk_bf16_f32 v97, v98, v99
    v_mfma_f32_16x16x32_bf16 v[56:59], v[60:63], v[64:67], 0
    v_cvt_pk_bf16_f32 v98, v100, v101
    v_cvt_pk_bf16_f32 v99, v102, v103
    v_cvt_pk_bf16_f32 v100, v104, v105
    v_cvt_pk_bf16_f32 v101, v106, v107
    v_mfma_f32_16x16x32_bf16 v[56:59], v[60:63], v[68:71], v[56:59]
    v_cvt_pk_bf16_f32 v102, v108, v109
    v_cvt_pk_bf16_f32 v103, v110, v111
    v_cvt_pk_bf16_f32 v104, v112, v113
    v_cvt_pk_bf16_f32 v105, v114, v115
    v_mfma_f32_16x16x32_bf16 v[56:59], v[60:63], v[72:75], v[56:59]
    v_cvt_pk_bf16_f32 v106, v116, v117
    v_cvt_pk_bf16_f32 v107, v118, v119
    v_cvt_pk_bf16_f32 v108, v120, v121
    v_cvt_pk_bf16_f32 v109, v122, v123
    v_mfma_f32_16x16x32_bf16 v[56:59], v[60:63], v[76:79], v[56:59]
    v_cvt_pk_bf16_f32 v110, v124, v125
    v_cvt_pk_bf16_f32 v111, v126, v127
    s_waitcnt lgkmcnt(0)
    v_mfma_f32_16x16x32_bf16 v[52:55], v[64:67], v[96:99], 0
    v_mfma_f32_16x16x32_bf16 v[52:55], v[68:71], v[100:103], v[52:55]
    v_mfma_f32_16x16x32_bf16 v[52:55], v[72:75], v[104:107], v[52:55]
    v_mfma_f32_16x16x32_bf16 v[52:55], v[76:79], v[108:111], v[52:55]
    v_and_b32 v3, 31, v1
    v_min_u32 v3, 16, v3
    v_lshlrev_b32 v3, 5, v3
    v_lshrrev_b32 v4, 5, v1
    v_lshl_add_u32 v3, v4, 4, v3
    v_add_u32 v3, 135168, v3
    v_cmp_ne_u32 vcc, 4, v2
    s_nop 0
    v_cvt_pk_bf16_f32 v52, v52, v53
    v_cvt_pk_bf16_f32 v53, v54, v55
    ds_write_b64 v5, v[52:53]
    ds_write_b32 v15, v56 offset:1024
    s_cbranch_vccz Lq0_done
    s_mov_b32 s62, 0
Lq0_top:
    ds_read_b32 v2, v12
    s_waitcnt lgkmcnt(0)
    v_cmp_ne_u32 vcc, 4, v2
    s_cbranch_vccz Lq0_done
    s_add_u32 s62, s62, 1
    s_cmp_lt_u32 s62, 1600000
    s_cbranch_scc1 Lq0_top
Lq0_done:
    ds_read_b64_tr_b16 v[16:17], v10 offset:0
    ds_read_b64_tr_b16 v[18:19], v10 offset:512
    ds_read_b64_tr_b16 v[20:21], v10 offset:2048
    ds_read_b64_tr_b16 v[22:23], v10 offset:2560
    ds_read_b64_tr_b16 v[24:25], v10 offset:4096
    ds_read_b64_tr_b16 v[26:27], v10 offset:4608
    ds_read_b64_tr_b16 v[28:29], v10 offset:6144
    ds_read_b64_tr_b16 v[30:31], v10 offset:6656
    ds_read_b64_tr_b16 v[32:33], v10 offset:8192
    ds_read_b64_tr_b16 v[34:35], v10 offset:8704
    ds_read_b64_tr_b16 v[36:37], v10 offset:10240
    ds_read_b64_tr_b16 v[38:39], v10 offset:10752
    ds_read_b64_tr_b16 v[40:41], v10 offset:12288
    ds_read_b64_tr_b16 v[42:43], v10 offset:12800
    s_waitcnt lgkmcnt(10)
    v_mfma_f32_32x32x16_bf16 v[64:79], v[16:19], v[128:131], 1.0
    ds_read_b64_tr_b16 v[44:45], v10 offset:14336
    ds_read_b64_tr_b16 v[46:47], v10 offset:14848
    v_mfma_f32_32x32x16_bf16 v[64:79], v[20:23], v[132:135], v[64:79]
    ds_read_b64_tr_b16 v[16:17], v10 offset:16384
    ds_read_b64_tr_b16 v[18:19], v10 offset:16896
    s_waitcnt lgkmcnt(10)
    v_mfma_f32_32x32x16_bf16 v[64:79], v[24:27], v[136:139], v[64:79]
    ds_read_b64_tr_b16 v[20:21], v10 offset:18432
    ds_read_b64_tr_b16 v[22:23], v10 offset:18944
    v_mfma_f32_32x32x16_bf16 v[64:79], v[28:31], v[140:143], v[64:79]
    ds_read_b64_tr_b16 v[24:25], v10 offset:20480
    ds_read_b64_tr_b16 v[26:27], v10 offset:20992
    s_waitcnt lgkmcnt(10)
    v_mfma_f32_32x32x16_bf16 v[64:79], v[32:35], v[144:147], v[64:79]
    ds_read_b64_tr_b16 v[28:29], v10 offset:22528
    ds_read_b64_tr_b16 v[30:31], v10 offset:23040
    v_mfma_f32_32x32x16_bf16 v[64:79], v[36:39], v[148:151], v[64:79]
    ds_read_b64_tr_b16 v[32:33], v10 offset:24576
    ds_read_b64_tr_b16 v[34:35], v10 offset:25088
    s_waitcnt lgkmcnt(10)
    v_mfma_f32_32x32x16_bf16 v[64:79], v[40:43], v[152:155], v[64:79]
    ds_read_b64_tr_b16 v[36:37], v10 offset:26624
    ds_read_b64_tr_b16 v[38:39], v10 offset:27136
    v_mfma_f32_32x32x16_bf16 v[64:79], v[44:47], v[156:159], v[64:79]
    ds_read_b64_tr_b16 v[40:41], v10 offset:28672
    ds_read_b64_tr_b16 v[42:43], v10 offset:29184
    s_waitcnt lgkmcnt(10)
    v_mfma_f32_32x32x16_bf16 v[64:79], v[16:19], v[160:163], v[64:79]
    ds_read_b64_tr_b16 v[44:45], v10 offset:30720
    ds_read_b64_tr_b16 v[46:47], v10 offset:31232
    v_mfma_f32_32x32x16_bf16 v[64:79], v[20:23], v[164:167], v[64:79]
    ds_read_b64_tr_b16 v[16:17], v10 offset:32768
    ds_read_b64_tr_b16 v[18:19], v10 offset:33280
    s_waitcnt lgkmcnt(10)
    v_mfma_f32_32x32x16_bf16 v[64:79], v[24:27], v[168:171], v[64:79]
    ds_read_b64_tr_b16 v[20:21], v10 offset:34816
    ds_read_b64_tr_b16 v[22:23], v10 offset:35328
    v_mfma_f32_32x32x16_bf16 v[64:79], v[28:31], v[172:175], v[64:79]
    ds_read_b64_tr_b16 v[24:25], v10 offset:36864
    ds_read_b64_tr_b16 v[26:27], v10 offset:37376
    s_waitcnt lgkmcnt(10)
    v_mfma_f32_32x32x16_bf16 v[64:79], v[32:35], v[176:179], v[64:79]
    ds_read_b64_tr_b16 v[28:29], v10 offset:38912
    ds_read_b64_tr_b16 v[30:31], v10 offset:39424
    v_mfma_f32_32x32x16_bf16 v[64:79], v[36:39], v[180:183], v[64:79]
    ds_read_b64_tr_b16 v[32:33], v10 offset:40960
    ds_read_b64_tr_b16 v[34:35], v10 offset:41472
    s_waitcnt lgkmcnt(10)
    v_mfma_f32_32x32x16_bf16 v[64:79], v[40:43], v[184:187], v[64:79]
    ds_read_b64_tr_b16 v[36:37], v10 offset:43008
    ds_read_b64_tr_b16 v[38:39], v10 offset:43520
    v_mfma_f32_32x32x16_bf16 v[64:79], v[44:47], v[188:191], v[64:79]
    ds_read_b64_tr_b16 v[40:41], v10 offset:45056
    ds_read_b64_tr_b16 v[42:43], v10 offset:45568
    s_waitcnt lgkmcnt(10)
    v_mfma_f32_32x32x16_bf16 v[64:79], v[16:19], v[192:195], v[64:79]
    ds_read_b64_tr_b16 v[44:45], v10 offset:47104
    ds_read_b64_tr_b16 v[46:47], v10 offset:47616
    v_mfma_f32_32x32x16_bf16 v[64:79], v[20:23], v[196:199], v[64:79]
    ds_read_b64_tr_b16 v[16:17], v10 offset:49152
    ds_read_b64_tr_b16 v[18:19], v10 offset:49664
    s_waitcnt lgkmcnt(10)
    v_mfma_f32_32x32x16_bf16 v[64:79], v[24:27], v[200:203], v[64:79]
    ds_read_b64_tr_b16 v[20:21], v10 offset:51200
    ds_read_b64_tr_b16 v[22:23], v10 offset:51712
    v_mfma_f32_32x32x16_bf16 v[64:79], v[28:31], v[204:207], v[64:79]
    ds_read_b64_tr_b16 v[24:25], v10 offset:53248
    ds_read_b64_tr_b16 v[26:27], v10 offset:53760
    s_waitcnt lgkmcnt(10)
    v_mfma_f32_32x32x16_bf16 v[64:79], v[32:35], v[208:211], v[64:79]
    ds_read_b64_tr_b16 v[28:29], v10 offset:55296
    ds_read_b64_tr_b16 v[30:31], v10 offset:55808
    v_mfma_f32_32x32x16_bf16 v[64:79], v[36:39], v[212:215], v[64:79]
    ds_read_b64_tr_b16 v[32:33], v10 offset:57344
    ds_read_b64_tr_b16 v[34:35], v10 offset:57856
    s_waitcnt lgkmcnt(10)
    v_mfma_f32_32x32x16_bf16 v[64:79], v[40:43], v[216:219], v[64:79]
    ds_read_b64_tr_b16 v[36:37], v10 offset:59392
    ds_read_b64_tr_b16 v[38:39], v10 offset:59904
    v_mfma_f32_32x32x16_bf16 v[64:79], v[44:47], v[220:223], v[64:79]
    ds_read_b64_tr_b16 v[40:41], v10 offset:61440
    ds_read_b64_tr_b16 v[42:43], v10 offset:61952
    s_waitcnt lgkmcnt(10)
    v_mfma_f32_32x32x16_bf16 v[64:79], v[16:19], v[224:227], v[64:79]
    ds_read_b64_tr_b16 v[44:45], v10 offset:63488
    ds_read_b64_tr_b16 v[46:47], v10 offset:64000
    v_mfma_f32_32x32x16_bf16 v[64:79], v[20:23], v[228:231], v[64:79]
    ds_read_b64_tr_b16 v[16:17], v11 offset:0
    ds_read_b64_tr_b16 v[18:19], v11 offset:512
    s_waitcnt lgkmcnt(10)
    v_mfma_f32_32x32x16_bf16 v[64:79], v[24:27], v[232:235], v[64:79]
    ds_read_b64_tr_b16 v[20:21], v11 offset:2048
    ds_read_b64_tr_b16 v[22:23], v11 offset:2560
    v_mfma_f32_32x32x16_bf16 v[64:79], v[28:31], v[236:239], v[64:79]
    ds_read_b64_tr_b16 v[24:25], v11 offset:4096
    ds_read_b64_tr_b16 v[26:27], v11 offset:4608
    s_waitcnt lgkmcnt(10)
    v_mfma_f32_32x32x16_bf16 v[64:79], v[32:35], v[240:243], v[64:79]
    ds_read_b64_tr_b16 v[28:29], v11 offset:6144
    ds_read_b64_tr_b16 v[30:31], v11 offset:6656
    v_mfma_f32_32x32x16_bf16 v[64:79], v[36:39], v[244:247], v[64:79]
    ds_read_b64_tr_b16 v[32:33], v11 offset:8192
    ds_read_b64_tr_b16 v[34:35], v11 offset:8704
    s_waitcnt lgkmcnt(10)
    v_mfma_f32_32x32x16_bf16 v[64:79], v[40:43], v[248:251], v[64:79]
    ds_read_b64_tr_b16 v[36:37], v11 offset:10240
    ds_read_b64_tr_b16 v[38:39], v11 offset:10752
    v_mfma_f32_32x32x16_bf16 v[64:79], v[44:47], v[252:255], v[64:79]
    ds_read_b64_tr_b16 v[40:41], v11 offset:12288
    ds_read_b64_tr_b16 v[42:43], v11 offset:12800
    s_waitcnt lgkmcnt(10)
    v_mfma_f32_32x32x16_bf16 v[80:95], v[16:19], v[128:131], 1.0
    ds_read_b64_tr_b16 v[44:45], v11 offset:14336
    ds_read_b64_tr_b16 v[46:47], v11 offset:14848
    v_mfma_f32_32x32x16_bf16 v[80:95], v[20:23], v[132:135], v[80:95]
    ds_read_b64_tr_b16 v[16:17], v11 offset:16384
    ds_read_b64_tr_b16 v[18:19], v11 offset:16896
    s_waitcnt lgkmcnt(10)
    v_mfma_f32_32x32x16_bf16 v[80:95], v[24:27], v[136:139], v[80:95]
    ds_read_b64_tr_b16 v[20:21], v11 offset:18432
    ds_read_b64_tr_b16 v[22:23], v11 offset:18944
    v_mfma_f32_32x32x16_bf16 v[80:95], v[28:31], v[140:143], v[80:95]
    v_fma_f32 v96, v64, s36, -s36
    v_fma_f32 v97, v65, s36, -s36
    ds_read_b64_tr_b16 v[24:25], v11 offset:20480
    ds_read_b64_tr_b16 v[26:27], v11 offset:20992
    s_waitcnt lgkmcnt(10)
    v_mfma_f32_32x32x16_bf16 v[80:95], v[32:35], v[144:147], v[80:95]
    v_fma_f32 v98, v66, s36, -s36
    v_fma_f32 v99, v67, s36, -s36
    ds_read_b64_tr_b16 v[28:29], v11 offset:22528
    ds_read_b64_tr_b16 v[30:31], v11 offset:23040
    v_mfma_f32_32x32x16_bf16 v[80:95], v[36:39], v[148:151], v[80:95]
    v_fma_f32 v100, v68, s36, -s36
    v_fma_f32 v101, v69, s36, -s36
    ds_read_b64_tr_b16 v[32:33], v11 offset:24576
    ds_read_b64_tr_b16 v[34:35], v11 offset:25088
    s_waitcnt lgkmcnt(10)
    v_mfma_f32_32x32x16_bf16 v[80:95], v[40:43], v[152:155], v[80:95]
    v_fma_f32 v102, v70, s36, -s36
    v_fma_f32 v103, v71, s36, -s36
    ds_read_b64_tr_b16 v[36:37], v11 offset:26624
    ds_read_b64_tr_b16 v[38:39], v11 offset:27136
    v_mfma_f32_32x32x16_bf16 v[80:95], v[44:47], v[156:159], v[80:95]
    v_fma_f32 v104, v72, s36, -s36
    v_fma_f32 v105, v73, s36, -s36
    ds_read_b64_tr_b16 v[40:41], v11 offset:28672
    ds_read_b64_tr_b16 v[42:43], v11 offset:29184
    s_waitcnt lgkmcnt(10)
    v_mfma_f32_32x32x16_bf16 v[80:95], v[16:19], v[160:163], v[80:95]
    v_fma_f32 v106, v74, s36, -s36
    v_fma_f32 v107, v75, s36, -s36
    ds_read_b64_tr_b16 v[44:45], v11 offset:30720
    ds_read_b64_tr_b16 v[46:47], v11 offset:31232
    v_mfma_f32_32x32x16_bf16 v[80:95], v[20:23], v[164:167], v[80:95]
    v_fma_f32 v108, v76, s36, -s36
    v_fma_f32 v109, v77, s36, -s36
    ds_read_b64_tr_b16 v[16:17], v11 offset:32768
    ds_read_b64_tr_b16 v[18:19], v11 offset:33280
    s_waitcnt lgkmcnt(10)
    v_mfma_f32_32x32x16_bf16 v[80:95], v[24:27], v[168:171], v[80:95]
    v_fma_f32 v110, v78, s36, -s36
    v_fma_f32 v111, v79, s36, -s36
    ds_read_b64_tr_b16 v[20:21], v11 offset:34816
    ds_read_b64_tr_b16 v[22:23], v11 offset:35328
    v_mfma_f32_32x32x16_bf16 v[80:95], v[28:31], v[172:175], v[80:95]
    v_exp_f32 v96, v96 clamp
    v_exp_f32 v97, v97 clamp
    ds_read_b64_tr_b16 v[24:25], v11 offset:36864
    ds_read_b64_tr_b16 v[26:27], v11 offset:37376
    s_waitcnt lgkmcnt(10)
    v_mfma_f32_32x32x16_bf16 v[80:95], v[32:35], v[176:179], v[80:95]
    v_exp_f32 v98, v98 clamp
    v_max_f32 v64, v64, v96
    ds_read_b64_tr_b16 v[28:29], v11 offset:38912
    ds_read_b64_tr_b16 v[30:31], v11 offset:39424
    v_mfma_f32_32x32x16_bf16 v[80:95], v[36:39], v[180:183], v[80:95]
    v_exp_f32 v99, v99 clamp
    v_max_f32 v65, v65, v97
    ds_read_b64_tr_b16 v[32:33], v11 offset:40960
    ds_read_b64_tr_b16 v[34:35], v11 offset:41472
    s_waitcnt lgkmcnt(10)
    v_mfma_f32_32x32x16_bf16 v[80:95], v[40:43], v[184:187], v[80:95]
    v_exp_f32 v100, v100 clamp
    v_max_f32 v66, v66, v98
    ds_read_b64_tr_b16 v[36:37], v11 offset:43008
    ds_read_b64_tr_b16 v[38:39], v11 offset:43520
    v_mfma_f32_32x32x16_bf16 v[80:95], v[44:47], v[188:191], v[80:95]
    v_exp_f32 v101, v101 clamp
    v_max_f32 v67, v67, v99
    ds_read_b64_tr_b16 v[40:41], v11 offset:45056
    ds_read_b64_tr_b16 v[42:43], v11 offset:45568
    s_waitcnt lgkmcnt(10)
    v_mfma_f32_32x32x16_bf16 v[80:95], v[16:19], v[192:195], v[80:95]
    v_exp_f32 v102, v102 clamp
    v_max_f32 v68, v68, v100
    ds_read_b64_tr_b16 v[44:45], v11 offset:47104
    ds_read_b64_tr_b16 v[46:47], v11 offset:47616
    v_mfma_f32_32x32x16_bf16 v[80:95], v[20:23], v[196:199], v[80:95]
    v_exp_f32 v103, v103 clamp
    v_max_f32 v69, v69, v101
    ds_read_b64_tr_b16 v[16:17], v11 offset:49152
    ds_read_b64_tr_b16 v[18:19], v11 offset:49664
    s_waitcnt lgkmcnt(10)
    v_mfma_f32_32x32x16_bf16 v[80:95], v[24:27], v[200:203], v[80:95]
    v_exp_f32 v104, v104 clamp
    v_max_f32 v70, v70, v102
    ds_read_b64_tr_b16 v[20:21], v11 offset:51200
    ds_read_b64_tr_b16 v[22:23], v11 offset:51712
    v_mfma_f32_32x32x16_bf16 v[80:95], v[28:31], v[204:207], v[80:95]
    v_exp_f32 v105, v105 clamp
    v_max_f32 v71, v71, v103
    ds_read_b64_tr_b16 v[24:25], v11 offset:53248
    ds_read_b64_tr_b16 v[26:27], v11 offset:53760
    s_waitcnt lgkmcnt(10)
    v_mfma_f32_32x32x16_bf16 v[80:95], v[32:35], v[208:211], v[80:95]
    v_exp_f32 v106, v106 clamp
    v_max_f32 v72, v72, v104
    ds_read_b64_tr_b16 v[28:29], v11 offset:55296
    ds_read_b64_tr_b16 v[30:31], v11 offset:55808
    v_mfma_f32_32x32x16_bf16 v[80:95], v[36:39], v[212:215], v[80:95]
    v_exp_f32 v107, v107 clamp
    v_max_f32 v73, v73, v105
    ds_read_b64_tr_b16 v[32:33], v11 offset:57344
    ds_read_b64_tr_b16 v[34:35], v11 offset:57856
    s_waitcnt lgkmcnt(10)
    v_mfma_f32_32x32x16_bf16 v[80:95], v[40:43], v[216:219], v[80:95]
    v_exp_f32 v108, v108 clamp
    v_max_f32 v74, v74, v106
    ds_read_b64_tr_b16 v[36:37], v11 offset:59392
    ds_read_b64_tr_b16 v[38:39], v11 offset:59904
    v_mfma_f32_32x32x16_bf16 v[80:95], v[44:47], v[220:223], v[80:95]
    v_exp_f32 v109, v109 clamp
    v_max_f32 v75, v75, v107
    ds_read_b64_tr_b16 v[40:41], v11 offset:61440
    ds_read_b64_tr_b16 v[42:43], v11 offset:61952
    s_waitcnt lgkmcnt(10)
    v_mfma_f32_32x32x16_bf16 v[80:95], v[16:19], v[224:227], v[80:95]
    v_exp_f32 v110, v110 clamp
    v_max_f32 v76, v76, v108
    ds_read_b64_tr_b16 v[44:45], v11 offset:63488
    ds_read_b64_tr_b16 v[46:47], v11 offset:64000
    v_mfma_f32_32x32x16_bf16 v[80:95], v[20:23], v[228:231], v[80:95]
    v_exp_f32 v111, v111 clamp
    v_max_f32 v77, v77, v109
    s_waitcnt lgkmcnt(8)
    v_mfma_f32_32x32x16_bf16 v[80:95], v[24:27], v[232:235], v[80:95]
    v_max_f32 v78, v78, v110
    v_max_f32 v79, v79, v111
    v_mfma_f32_32x32x16_bf16 v[80:95], v[28:31], v[236:239], v[80:95]
    v_add_f32 v64, s38, v64
    v_add_f32 v65, s38, v65
    s_waitcnt lgkmcnt(4)
    v_mfma_f32_32x32x16_bf16 v[80:95], v[32:35], v[240:243], v[80:95]
    v_add_f32 v66, s38, v66
    v_add_f32 v67, s38, v67
    v_mfma_f32_32x32x16_bf16 v[80:95], v[36:39], v[244:247], v[80:95]
    v_add_f32 v68, s38, v68
    v_add_f32 v69, s38, v69
    s_waitcnt lgkmcnt(0)
    v_mfma_f32_32x32x16_bf16 v[80:95], v[40:43], v[248:251], v[80:95]
    v_add_f32 v70, s38, v70
    v_add_f32 v71, s38, v71
    v_mfma_f32_32x32x16_bf16 v[80:95], v[44:47], v[252:255], v[80:95]
    v_add_f32 v72, s38, v72
    v_add_f32 v73, s38, v73
    v_add_f32 v74, s38, v74
    v_add_f32 v75, s38, v75
    v_add_f32 v76, s38, v76
    v_add_f32 v77, s38, v77
    v_add_f32 v78, s38, v78
    v_add_f32 v79, s38, v79
    v_cvt_pk_bf16_f32 v64, v64, v65
    v_cvt_pk_bf16_f32 v65, v66, v67
    v_cvt_pk_bf16_f32 v66, v68, v69
    v_cvt_pk_bf16_f32 v67, v70, v71
    v_cvt_pk_bf16_f32 v68, v72, v73
    v_cvt_pk_bf16_f32 v69, v74, v75
    v_cvt_pk_bf16_f32 v70, v76, v77
    v_cvt_pk_bf16_f32 v71, v78, v79
    v_pk_fma_f32 v[96:97], v[80:81], s[36:37], s[36:37] neg_lo:[0,0,1] neg_hi:[0,0,1]
    v_pk_fma_f32 v[98:99], v[82:83], s[36:37], s[36:37] neg_lo:[0,0,1] neg_hi:[0,0,1]
    v_pk_fma_f32 v[100:101], v[84:85], s[36:37], s[36:37] neg_lo:[0,0,1] neg_hi:[0,0,1]
    v_pk_fma_f32 v[102:103], v[86:87], s[36:37], s[36:37] neg_lo:[0,0,1] neg_hi:[0,0,1]
    v_pk_fma_f32 v[104:105], v[88:89], s[36:37], s[36:37] neg_lo:[0,0,1] neg_hi:[0,0,1]
    v_pk_fma_f32 v[106:107], v[90:91], s[36:37], s[36:37] neg_lo:[0,0,1] neg_hi:[0,0,1]
    v_pk_fma_f32 v[108:109], v[92:93], s[36:37], s[36:37] neg_lo:[0,0,1] neg_hi:[0,0,1]
    v_pk_fma_f32 v[110:111], v[94:95], s[36:37], s[36:37] neg_lo:[0,0,1] neg_hi:[0,0,1]
    v_exp_f32 v96, v96 clamp
    v_exp_f32 v97, v97 clamp
    v_exp_f32 v98, v98 clamp
    v_max_f32 v80, v80, v96
    v_exp_f32 v99, v99 clamp
    v_max_f32 v81, v81, v97
    v_exp_f32 v100, v100 clamp
    v_max_f32 v82, v82, v98
    v_exp_f32 v101, v101 clamp
    v_max_f32 v83, v83, v99
    v_exp_f32 v102, v102 clamp
    v_max_f32 v84, v84, v100
    v_exp_f32 v103, v103 clamp
    v_max_f32 v85, v85, v101
    v_exp_f32 v104, v104 clamp
    v_max_f32 v86, v86, v102
    v_exp_f32 v105, v105 clamp
    v_max_f32 v87, v87, v103
    v_exp_f32 v106, v106 clamp
    v_max_f32 v88, v88, v104
    v_exp_f32 v107, v107 clamp
    v_max_f32 v89, v89, v105
    v_exp_f32 v108, v108 clamp
    v_max_f32 v90, v90, v106
    v_exp_f32 v109, v109 clamp
    v_max_f32 v91, v91, v107
    v_exp_f32 v110, v110 clamp
    v_max_f32 v92, v92, v108
    v_exp_f32 v111, v111 clamp
    v_max_f32 v93, v93, v109
    v_max_f32 v94, v94, v110
    v_max_f32 v95, v95, v111
    v_pk_add_f32 v[80:81], v[80:81], s[38:39]
    v_pk_add_f32 v[82:83], v[82:83], s[38:39]
    v_pk_add_f32 v[84:85], v[84:85], s[38:39]
    v_pk_add_f32 v[86:87], v[86:87], s[38:39]
    v_pk_add_f32 v[88:89], v[88:89], s[38:39]
    v_pk_add_f32 v[90:91], v[90:91], s[38:39]
    ds_read_b32 v2, v12 offset:4
    v_pk_add_f32 v[92:93], v[92:93], s[38:39]
    v_pk_add_f32 v[94:95], v[94:95], s[38:39]
    v_cvt_pk_bf16_f32 v80, v80, v81
    v_cvt_pk_bf16_f32 v81, v82, v83
    v_cvt_pk_bf16_f32 v82, v84, v85
    v_cvt_pk_bf16_f32 v83, v86, v87
    v_cvt_pk_bf16_f32 v84, v88, v89
    v_cvt_pk_bf16_f32 v85, v90, v91
    v_cvt_pk_bf16_f32 v86, v92, v93
    v_cvt_pk_bf16_f32 v87, v94, v95
    s_waitcnt lgkmcnt(0)
    v_cmp_ne_u32 vcc, 4, v2
    s_cbranch_vccz Lkvw_done
    s_mov_b32 s62, 0
Lkvw_top:
    ds_read_b32 v2, v12 offset:4
    s_waitcnt lgkmcnt(0)
    v_cmp_ne_u32 vcc, 4, v2
    s_cbranch_vccz Lkvw_done
    s_add_u32 s62, s62, 1
    s_cmp_lt_u32 s62, 1600000
    s_cbranch_scc1 Lkvw_top
Lkvw_done:
    ds_read_b128 v[16:19], v3 offset:0
    ds_read_b128 v[20:23], v3 offset:1024
    ds_read_b128 v[24:27], v3 offset:2048
    ds_read_b128 v[28:31], v3 offset:3072
    s_waitcnt lgkmcnt(3)
    v_mfma_f32_32x32x16_bf16 v[192:207], v[16:19], v[64:67], 0
    s_waitcnt lgkmcnt(2)
    v_mfma_f32_32x32x16_bf16 v[208:223], v[20:23], v[68:71], 0
    s_waitcnt lgkmcnt(1)
    v_mfma_f32_32x32x16_bf16 v[224:239], v[24:27], v[80:83], 0
    s_waitcnt lgkmcnt(0)
    v_mfma_f32_32x32x16_bf16 v[240:255], v[28:31], v[84:87], 0
    s_add_u32 s61, s50, 0
    s_and_b32 s61, s61, 7
    s_lshl_b32 s61, s61, 12
    s_add_u32 s61, s61, s66
    s_add_u32 m0, s67, 0
    s_xor_b32 s61, s61, 0x10000
    v_add_f32 v200, s38, v200
    v_rcp_f32 v200, v200
    s_nop 0
    v_pk_mul_f32 v[192:193], v[192:193], v[200:201] op_sel_hi:[1,0]
    v_pk_mul_f32 v[194:195], v[194:195], v[200:201] op_sel_hi:[1,0]
    v_pk_mul_f32 v[196:197], v[196:197], v[200:201] op_sel_hi:[1,0]
    v_pk_mul_f32 v[198:199], v[198:199], v[200:201] op_sel_hi:[1,0]
    v_cvt_pk_bf16_f32 v192, v192, v193
    v_cvt_pk_bf16_f32 v193, v194, v195
    v_cvt_pk_bf16_f32 v194, v196, v197
    v_cvt_pk_bf16_f32 v195, v198, v199
    buffer_store_dwordx4 v[192:195], v14, s[40:43], s68 offen offset:0 sc1
    v_add_f32 v216, s38, v216
    v_rcp_f32 v216, v216
    s_nop 0
    v_pk_mul_f32 v[208:209], v[208:209], v[216:217] op_sel_hi:[1,0]
    v_pk_mul_f32 v[210:211], v[210:211], v[216:217] op_sel_hi:[1,0]
    v_pk_mul_f32 v[212:213], v[212:213], v[216:217] op_sel_hi:[1,0]
    v_pk_mul_f32 v[214:215], v[214:215], v[216:217] op_sel_hi:[1,0]
    v_cvt_pk_bf16_f32 v208, v208, v209
    v_cvt_pk_bf16_f32 v209, v210, v211
    v_cvt_pk_bf16_f32 v210, v212, v213
    v_cvt_pk_bf16_f32 v211, v214, v215
    buffer_store_dwordx4 v[208:211], v14, s[40:43], s68 offen offset:1024 sc1
    v_add_f32 v232, s38, v232
    v_rcp_f32 v232, v232
    s_nop 0
    v_pk_mul_f32 v[224:225], v[224:225], v[232:233] op_sel_hi:[1,0]
    v_pk_mul_f32 v[226:227], v[226:227], v[232:233] op_sel_hi:[1,0]
    v_pk_mul_f32 v[228:229], v[228:229], v[232:233] op_sel_hi:[1,0]
    v_pk_mul_f32 v[230:231], v[230:231], v[232:233] op_sel_hi:[1,0]
    v_cvt_pk_bf16_f32 v224, v224, v225
    v_cvt_pk_bf16_f32 v225, v226, v227
    v_cvt_pk_bf16_f32 v226, v228, v229
    v_cvt_pk_bf16_f32 v227, v230, v231
    buffer_store_dwordx4 v[224:227], v14, s[40:43], s68 offen offset:2048 sc1
    v_add_f32 v248, s38, v248
    v_rcp_f32 v248, v248
    s_nop 0
    v_pk_mul_f32 v[240:241], v[240:241], v[248:249] op_sel_hi:[1,0]
    v_pk_mul_f32 v[242:243], v[242:243], v[248:249] op_sel_hi:[1,0]
    v_pk_mul_f32 v[244:245], v[244:245], v[248:249] op_sel_hi:[1,0]
    v_pk_mul_f32 v[246:247], v[246:247], v[248:249] op_sel_hi:[1,0]
    v_cvt_pk_bf16_f32 v240, v240, v241
    v_cvt_pk_bf16_f32 v241, v242, v243
    v_cvt_pk_bf16_f32 v242, v244, v245
    v_cvt_pk_bf16_f32 v243, v246, v247
    buffer_store_dwordx4 v[240:243], v14, s[40:43], s68 offen offset:3072 sc1
    s_mov_b64 exec, 1
    ds_add_u32 v12, v13 offset:8
    s_mov_b64 exec, -1
    s_waitcnt vmcnt(0)
    s_atomic_add s51, s[22:23], s69
    s_atomic_add s51, s[22:23], s69 offset:256
    s_atomic_add s51, s[22:23], s69 offset:512
    s_atomic_add s51, s[22:23], s69 offset:768

    s_bitcmp1_b32 s58, 0
    s_cbranch_scc1 Lpollo_done
    s_mov_b32 s62, 0
Lpollo_top:
    s_load_dword s65, s[22:23], s9 glc
    s_waitcnt lgkmcnt(0)
    s_cmp_eq_u32 s65, 16
    s_cbranch_scc1 Lpollo_done
    s_sleep 2
    s_add_u32 s62, s62, 1
    s_cmp_lt_u32 s62, 200000
    s_cbranch_scc1 Lpollo_top
Lpollo_done:
    s_barrier
    buffer_load_dwordx4 v14, s[40:43], s61 offen sc1 lds
    buffer_load_dwordx4 v14, s[40:43], s61 offen offset:1024 sc1 lds
    buffer_load_dwordx4 v14, s[40:43], s61 offen offset:2048 sc1 lds
    buffer_load_dwordx4 v14, s[40:43], s61 offen offset:3072 sc1 lds
    s_add_u32 s61, s50, 2
    s_and_b32 s61, s61, 7
    s_lshl_b32 s61, s61, 12
    s_add_u32 s61, s61, s66
    s_add_u32 m0, s67, 4096
    s_xor_b32 s61, s61, 0x10000
    buffer_load_dwordx4 v14, s[40:43], s61 offen sc1 lds
    buffer_load_dwordx4 v14, s[40:43], s61 offen offset:1024 sc1 lds
    buffer_load_dwordx4 v14, s[40:43], s61 offen offset:2048 sc1 lds
    buffer_load_dwordx4 v14, s[40:43], s61 offen offset:3072 sc1 lds
    s_add_u32 s61, s50, 4
    s_and_b32 s61, s61, 7
    s_lshl_b32 s61, s61, 12
    s_add_u32 s61, s61, s66
    s_add_u32 m0, s67, 32768
    s_xor_b32 s61, s61, 0x10000
    buffer_load_dwordx4 v14, s[40:43], s61 offen sc1 lds
    buffer_load_dwordx4 v14, s[40:43], s61 offen offset:1024 sc1 lds
    buffer_load_dwordx4 v14, s[40:43], s61 offen offset:2048 sc1 lds
    buffer_load_dwordx4 v14, s[40:43], s61 offen offset:3072 sc1 lds
    s_add_u32 s61, s50, 6
    s_and_b32 s61, s61, 7
    s_lshl_b32 s61, s61, 12
    s_add_u32 s61, s61, s66
    s_add_u32 m0, s67, 36864
    s_xor_b32 s61, s61, 0x10000
    buffer_load_dwordx4 v14, s[40:43], s61 offen sc1 lds
    buffer_load_dwordx4 v14, s[40:43], s61 offen offset:1024 sc1 lds
    buffer_load_dwordx4 v14, s[40:43], s61 offen offset:2048 sc1 lds
    buffer_load_dwordx4 v14, s[40:43], s61 offen offset:3072 sc1 lds
    s_waitcnt vmcnt(8)
    s_barrier
    s_add_u32 s61, s50, 0
    s_and_b32 s61, s61, 7
    s_lshl_b32 s61, s61, 12
    s_add_u32 s61, s61, s66
    s_add_u32 m0, s67, 65536
    s_nop 0
    buffer_load_dwordx4 v14, s[40:43], s61 offen sc1 lds
    buffer_load_dwordx4 v14, s[40:43], s61 offen offset:1024 sc1 lds
    buffer_load_dwordx4 v14, s[40:43], s61 offen offset:2048 sc1 lds
    buffer_load_dwordx4 v14, s[40:43], s61 offen offset:3072 sc1 lds
    s_add_u32 s61, s50, 2
    s_and_b32 s61, s61, 7
    s_lshl_b32 s61, s61, 12
    s_add_u32 s61, s61, s66
    s_add_u32 m0, s67, 69632
    s_nop 0
    buffer_load_dwordx4 v14, s[40:43], s61 offen sc1 lds
    buffer_load_dwordx4 v14, s[40:43], s61 offen offset:1024 sc1 lds
    buffer_load_dwordx4 v14, s[40:43], s61 offen offset:2048 sc1 lds
    buffer_load_dwordx4 v14, s[40:43], s61 offen offset:3072 sc1 lds
    s_waitcnt vmcnt(8)
    s_barrier
    s_add_u32 s61, s50, 4
    s_and_b32 s61, s61, 7
    s_lshl_b32 s61, s61, 12
    s_add_u32 s61, s61, s66
    s_add_u32 m0, s67, 98304
    s_nop 0
    buffer_load_dwordx4 v14, s[40:43], s61 offen sc1 lds
    buffer_load_dwordx4 v14, s[40:43], s61 offen offset:1024 sc1 lds
    buffer_load_dwordx4 v14, s[40:43], s61 offen offset:2048 sc1 lds
    buffer_load_dwordx4 v14, s[40:43], s61 offen offset:3072 sc1 lds
    s_add_u32 s61, s50, 6
    s_and_b32 s61, s61, 7
    s_lshl_b32 s61, s61, 12
    s_add_u32 s61, s61, s66
    s_add_u32 m0, s67, 102400
    s_nop 0
    buffer_load_dwordx4 v14, s[40:43], s61 offen sc1 lds
    buffer_load_dwordx4 v14, s[40:43], s61 offen offset:1024 sc1 lds
    buffer_load_dwordx4 v14, s[40:43], s61 offen offset:2048 sc1 lds
    buffer_load_dwordx4 v14, s[40:43], s61 offen offset:3072 sc1 lds
    s_waitcnt vmcnt(8)
    s_barrier
    s_waitcnt vmcnt(0)
    s_barrier
Lend:
    s_endpgm
Lzc:
    s_mov_b32 s62, 0
Lzc_top:
    s_load_dword s65, s[20:21], 0 glc
    s_waitcnt lgkmcnt(0)
    s_cmp_ge_u32 s65, 64
    s_cbranch_scc1 Lzc_done
    s_sleep 4
    s_add_u32 s62, s62, 1
    s_cmp_lt_u32 s62, 200000
    s_cbranch_scc1 Lzc_top
    s_branch Lzc_done
Lflag:
    s_waitcnt vmcnt(0)
    s_atomic_add s51, s[20:21], 0
    s_branch Lflag_done
Lcode_end:

.section .rodata,"a"
.p2align 6
.amdhsa_kernel gated_mix__linear_attn_block__linear_attn_block__prompt_kernel
  .amdhsa_next_free_vgpr 256
  .amdhsa_next_free_sgpr 102
  .amdhsa_accum_offset 256
  .amdhsa_group_segment_fixed_size 0
  .amdhsa_kernarg_size 80
  .amdhsa_user_sgpr_count 2
  .amdhsa_user_sgpr_kernarg_segment_ptr 1
  .amdhsa_system_sgpr_workgroup_id_x 1
.end_amdhsa_kernel
```
